```python
import torch

def _softmax(x, axis=-1):
    return torch.softmax(x, dim=axis)
def _gelu(x):
    return torch.nn.functional.gelu(x, approximate="tanh")
def _silu(x):
    return torch.nn.functional.silu(x)
def _sigmoid(x):
    return torch.sigmoid(x)
def _layernorm(x, axis=-1, eps=1e-5):
    m = x.mean(dim=axis, keepdim=True)
    v = x.var(dim=axis, keepdim=True, unbiased=False)
    return (x - m) / torch.sqrt(v + eps)
def _scatter_add(tgt, idx, src, axis=0):
    return tgt.clone().index_add_(axis, idx, src)
def _segment_sum(src, seg, n):
    out = torch.zeros((n,) + src.shape[1:], dtype=src.dtype)
    return out.index_add_(0, seg, src)
def _pad(x, pw):
    flat = tuple(v for pair in reversed(pw) for v in pair)
    return torch.nn.functional.pad(x, flat)

kernel_name = 'parallel_sum__ssm_conv_s4d__dense_activation_relu__prompt'

def setup_inputs():

    _w = (lambda a: (lambda t: t.to(torch.bfloat16) if t.is_floating_point() else t)(torch.as_tensor(a)))
    def _A_setup():
        Bsz, L, D, N = 1, 2048, 512, 128
        return {
            "u": _w((lambda *s: torch.randn(*s, dtype=torch.bfloat16) * 0.05)(Bsz, L, D)),
            "log_A_real": _w((lambda *s: torch.randn(*s, dtype=torch.bfloat16) * 6.4)(D, N) * 0.5),
            "A_imag": _w((lambda *s: torch.randn(*s, dtype=torch.bfloat16) * 0.1)(D, N) * 3.14),
            "C_real": _w((lambda *s: torch.randn(*s, dtype=torch.bfloat16) * 0.8)(D, N) / N ** 0.5),
            "C_imag": _w((lambda *s: torch.randn(*s, dtype=torch.bfloat16) * 0.8)(D, N) / N ** 0.5),
            "log_dt": _w((lambda *s: torch.randn(*s, dtype=torch.bfloat16) * 0.1)(D) * 0.5 - 4.0),
            "D_skip": _w((lambda *s: torch.randn(*s, dtype=torch.bfloat16) * 0.1)(D)),
        }
    _A_in = _A_setup()

    def _B_setup():
        B, S, D, Dff = 1, 2048, 512, 1376
        return {
            "x": _w((lambda *s: torch.randn(*s, dtype=torch.bfloat16) * 0.05)(B, S, D)),
            "w1": _w((lambda *s: torch.randn(*s, dtype=torch.bfloat16) * 0.05)(D, Dff)),
            "w2": _w((lambda *s: torch.randn(*s, dtype=torch.bfloat16) * 0.05)(Dff, D)),
        }
    _B_in = _B_setup()

    return {
        "A_u": _A_in["u"],
        "A_log_A_real": _A_in["log_A_real"],
        "A_A_imag": _A_in["A_imag"],
        "A_C_real": _A_in["C_real"],
        "A_C_imag": _A_in["C_imag"],
        "A_log_dt": _A_in["log_dt"],
        "A_D_skip": _A_in["D_skip"],
        "B_x": _B_in["x"],
        "B_w1": _B_in["w1"],
        "B_w2": _B_in["w2"],
    }

def reference(A_u, A_log_A_real, A_A_imag, A_C_real, A_C_imag, A_log_dt, A_D_skip, B_x, B_w1, B_w2):
    def _A_ref(u, log_A_real, A_imag, C_real, C_imag, log_dt, D_skip):
        L = u.shape[1]
        dt = torch.exp(log_dt)
        A = -torch.exp(log_A_real) + 1j * A_imag
        C = (C_real + 1j * C_imag) * dt[:, None]
        pos = (lambda x, dt: x.to(dt))(torch.arange(L), log_dt.dtype)
        P = torch.exp((A * dt[:, None])[:, :, None] * pos[None, None, :])
        K = 2.0 * torch.einsum("dn,dnl->dl", C, P).real
        L2 = 2 * L
        u_t = (lambda x, *d: x.permute(*d))(u, 0, 2, 1)
        Kf = (lambda x, *a, **k: torch.fft.rfft(x.float(), *a, **k))(K, L2)
        Uf = (lambda x, *a, **k: torch.fft.rfft(x.float(), *a, **k))(u_t, L2)
        y = (lambda x, *a, **k: torch.fft.irfft(x, *a, **k).to(torch.bfloat16))(Uf * Kf[None, :, :], L2)[:, :, :L]
        y = (lambda x, *d: x.permute(*d))(y, 0, 2, 1)
        return y + u * D_skip[None, None, :]

    def _B_ref(x, w1, w2):
        h = torch.einsum("bsd,df->bsf", x, w1)
        zero = torch.zeros_like(h)
        h = torch.maximum(h, zero)
        return torch.einsum("bsf,fd->bsd", h, w2)

    x = A_u
    xn = _layernorm(x, axis=-1)
    return x + _A_ref(xn, A_log_A_real, A_A_imag, A_C_real, A_C_imag, A_log_dt, A_D_skip) + _B_ref(xn, B_w1, B_w2)
```

```asm
; @launch grid=(256,1,1) block=(512,1,1) lds=163840
.amdgcn_target "amdgcn-amd-amdhsa--gfx950"
.text
.globl parallel_sum__ssm_conv_s4d__dense_activation_relu__prompt_kernel
.p2align 8
.type parallel_sum__ssm_conv_s4d__dense_activation_relu__prompt_kernel,@function
parallel_sum__ssm_conv_s4d__dense_activation_relu__prompt_kernel:
  s_cmp_ge_u32 s2, 256
  s_cbranch_scc1 L_exit
  s_load_dwordx16 s[16:31], s[0:1], 0
  s_load_dwordx8 s[32:39], s[0:1], 64
  s_load_dwordx2 s[40:41], s[0:1], 96
  s_memrealtime s[100:101]
  s_getpc_b64 s[98:99]
L_pc:
  s_lshr_b32 s3, s2, 3
  s_mul_i32 s3, s3, 1280
  v_lshlrev_b32 v255, 7, v0
  v_add_u32_e64 v255, s3, v255
  s_mov_b32 s3, L_codeend-L_pc-4
  v_min_u32 v255, s3, v255
  v_add_co_u32 v254, vcc, s98, v255
  v_mov_b32 v255, s99
  s_nop 0
  v_addc_co_u32 v255, vcc, 0, v255, vcc
  v_cmp_gt_u32 vcc, 10, v0
  s_and_b64 exec, exec, vcc
  s_cbranch_execz L_ncpf
  global_load_dword v255, v[254:255], off
L_ncpf:
  s_mov_b64 exec, -1
  v_lshrrev_b32 v3, 6, v0
  v_and_b32 v0, 63, v0
  v_readfirstlane_b32 s3, v3
  v_mov_b32_e64 v1, 0
  v_mov_b32 v2, 1
  s_mov_b32 s76, 200000
  s_and_b32 s4, s2, 7
  s_lshr_b32 s5, s2, 3
  s_xor_b32 s5, s5, 0
  s_lshr_b32 s15, s4, 1
  s_lshl_b32 s15, s15, 2
  s_and_b32 s77, s5, 3
  s_add_u32 s6, s15, s77
  s_lshl_b32 s15, s4, 2
  s_add_u32 s10, s15, s77
  s_lshr_b32 s11, s5, 2
  s_and_b32 s77, s4, 1
  s_lshl_b32 s15, s77, 3
  s_add_u32 s7, s15, s11
  s_lshl_b32 s15, s6, 4
  s_add_u32 s8, s15, s7
  s_lshl_b32 s15, s4, 5
  s_add_u32 s9, s15, s5
  s_mul_i32 s12, s77, 22
  s_mul_i32 s15, s11, 3
  s_add_u32 s12, s12, s15
  s_sub_u32 s77, 6, s77
  s_max_u32 s15, s11, s77
  s_sub_u32 s15, s15, s77
  s_sub_u32 s12, s12, s15
  s_cmp_lt_u32 s11, s77
  s_cselect_b32 s13, 3, 2
  s_and_b32 s42, s3, 3
  s_cmp_eq_u32 s11, 3
  s_cselect_b32 s15, 4, 0
  s_cmp_eq_u32 s11, 7
  s_cselect_b32 s15, 4, s15
  s_xor_b32 s11, s11, s15
  s_waitcnt lgkmcnt(0)
  s_mov_b32 s44, s40
  s_mov_b32 s45, s41
  s_mov_b32 s46, 13631488
  s_mov_b32 s47, 0x20000
  s_mov_b32 s72, s38
  s_mov_b32 s73, s39
  s_mov_b32 s74, 256
  s_mov_b32 s75, 0x20000
  s_cmp_lt_u32 s3, 4
  s_cbranch_scc1 L_G
  s_mov_b32 s48, s16
  s_mov_b32 s49, s17
  s_mov_b32 s50, 2097152
  s_mov_b32 s51, 0x20000
  s_setprio 3
  s_lshr_b32 s98, s42, 1
  s_and_b32 s99, s42, 1
  s_lshl_b32 s71, s9, 1
  s_add_u32 s71, s71, s98
  v_lshlrev_b32 v16, 4, v0
  s_lshl_b32 s77, s8, 13
  s_lshl_b32 s15, s42, 11
  s_add_u32 s77, s77, s15
  s_or_b32 s15, s2, s42
  s_cmp_lg_u32 s15, 0
  s_cbranch_scc1 L_nomaster
  s_or_b32 s15, s100, 1
  v_mov_b32 v12, s15
  s_mov_b64 exec, 1
  buffer_store_dword v12, v1, s[72:75], 0 offen sc1
  s_mov_b64 exec, -1
L_nomaster:
  buffer_load_dwordx4 v[4:7], v16, s[48:51], s77 offen
  buffer_load_dwordx4 v[8:11], v16, s[48:51], s77 offen offset:1024
  s_lshl_b32 s15, s9, 9
  s_lshl_b32 s77, s42, 7
  s_add_u32 s15, s15, s77
  v_lshl_add_u32 v17, v0, 1, s15
  s_lshl_b32 s15, s9, 2
  v_mov_b32_e64 v18, s15
  global_load_ushort v212, v17, s[18:19]
  global_load_dword v216, v18, s[26:27]
  global_load_ushort v213, v17, s[20:21]
  global_load_ushort v214, v17, s[22:23]
  global_load_ushort v215, v17, s[24:25]
  global_load_dword v20, v18, s[28:29]
  s_mul_i32 s56, s98, 4608
  s_add_u32 s56, s56, 128
  s_mul_i32 s57, s98, 8320
  s_add_u32 s57, s57, 9344
  s_lshl_b32 s15, s99, 8
  s_add_u32 s15, s15, s56
  v_lshl_add_u32 v22, v0, 2, s15
  ds_write_b32 v22, v1
  v_lshlrev_b32 v22, 1, v0
  v_and_b32 v22, 0x7c, v22
  ds_write_b32 v22, v1
  s_waitcnt lgkmcnt(0)
  s_barrier
  s_lshr_b32 s15, s42, 1
  s_lshl_b32 s77, s10, 1
  s_add_u32 s84, s77, s15
  s_and_b32 s85, s42, 1
  s_xor_b32 s15, s99, 1
  s_mul_i32 s15, s15, 4160
  s_add_u32 s86, s15, s57
  s_lshl_b32 s96, s42, 13
  s_add_u32 s96, s96, 50688
  v_lshlrev_b32 v25, 7, v0
  v_and_b32 v26, 7, v0
  v_lshl_add_u32 v25, v26, 4, v25
  v_xor_b32 v200, 0, v25
  v_add_u32 v200, s96, v200
  v_xor_b32 v201, 16, v25
  v_add_u32 v201, s96, v201
  v_xor_b32 v202, 32, v25
  v_add_u32 v202, s96, v202
  v_xor_b32 v203, 48, v25
  v_add_u32 v203, s96, v203
  v_xor_b32 v204, 64, v25
  v_add_u32 v204, s96, v204
  v_xor_b32 v205, 80, v25
  v_add_u32_e64 v205, s96, v205
  v_xor_b32 v206, 96, v25
  v_add_u32_e64 v206, s96, v206
  v_xor_b32 v207, 112, v25
  v_add_u32 v207, s96, v207
  s_lshl_b32 s15, s42, 2
  v_mov_b32 v210, s15
  v_lshrrev_b32 v25, 5, v0
  v_bfe_u32 v26, v0, 3, 1
  v_lshl_add_u32 v25, v25, 2, v26
  v_bfe_u32 v26, v0, 2, 1
  v_lshlrev_b32_e64 v26, 2, v26
  v_bfe_u32 v27, v0, 4, 1
  v_lshl_add_u32 v26, v27, 1, v26
  v_bfe_u32 v27, v0, 1, 1
  v_add_u32 v26, v26, v27
  v_xor_b32 v26, v26, v25
  v_lshlrev_b32_e64 v26, 4, v26
  v_lshl_add_u32 v26, v25, 7, v26
  v_and_b32_e64 v27, 1, v0
  v_lshl_add_u32 v26, v27, 3, v26
  v_add_u32 v208, s96, v26
  v_xor_b32 v26, 32, v26
  v_add_u32 v26, 256, v26
  v_add_u32_e64 v209, s96, v26
  s_mov_b32 s64, s34
  s_mov_b32 s65, s35
  s_mov_b32 s66, 1409024
  s_mov_b32 s67, 0x20000
  v_lshrrev_b32 v220, 3, v0
  v_lshlrev_b32 v220, 10, v220
  v_bfe_u32 v25, v0, 4, 1
  v_lshlrev_b32 v25, 2, v25
  v_and_b32 v26, 7, v0
  v_xor_b32_e64 v25, v25, v26
  v_lshl_add_u32 v220, v25, 4, v220
  v_add_u32 v221, 7168, v220
  s_mul_i32 s15, s10, 0
  s_mul_i32 s91, s11, 0
  s_add_u32 s15, s15, s91
  s_and_b32 s15, s15, 7
  s_mul_i32 s15, s15, 11
  s_lshr_b32 s15, s15, 2
  s_sub_u32 s89, 22, s15
  s_mul_i32 s91, s42, 22
  s_add_u32 s91, s91, s15
  s_lshl_b32 s88, s91, 14
  s_lshl_b32 s91, s91, 10
  s_lshl_b32 s15, s11, 7
  s_add_u32 s88, s88, s15
  s_sub_u32 s94, s88, 360448
  s_sub_u32 s95, s91, 22528
  s_lshl_b32 s90, s42, 11
  s_add_u32 s90, s90, 50688
  v_add_u32_e64 v243, s96, v16
  v_xor_b32 v244, 8192, v243
  s_mul_i32 s15, s99, 4160
  s_add_u32 s87, s15, s57
  s_lshl_b32 s15, s98, 2
  v_mov_b32 v245, s15
  v_and_b32 v26, 31, v0
  v_lshlrev_b32 v26, 4, v26
  v_lshrrev_b32 v27, 5, v0
  s_add_u32 s15, s87, 32
  v_add_u32 v26, s15, v26
  v_lshl_add_u32 v232, v27, 3, v26
  v_lshl_add_u32 v233, v27, 9, v26
  v_lshl_add_u32 v234, v27, 10, v26
  v_lshl_add_u32 v235, v0, 2, s87
  v_and_b32 v26, 15, v0
  v_lshrrev_b32 v27, 4, v0
  v_lshlrev_b32 v28, 3, v27
  v_sub_u32 v28, v26, v28
  v_add_u32 v28, 25, v28
  v_lshrrev_b32 v28, 1, v28
  v_and_b32 v31, 1, v0
  v_xor_b32 v31, 1, v31
  v_mul_u32_u24 v31, 4160, v31
  v_lshl_add_u32 v28, v28, 2, v31
  s_lshl_b32 s15, s99, 8
  s_add_u32 s77, s15, s57
  v_add_u32_e64 v236, s77, v28
  v_add_u32 v237, 1024, v236
  v_add_u32 v238, 2048, v236
  v_add_u32 v239, 3072, v236
  v_lshlrev_b32 v241, 4, v27
  v_lshl_add_u32 v28, v26, 5, v241
  s_sub_u32 s77, s56, s15
  s_add_u32 s77, s77, 288
  v_add_u32_e64 v240, s77, v28
  v_lshl_add_u32 v241, v26, 6, v241
  v_lshrrev_b32 v28, 1, v27
  v_lshlrev_b32 v28, 4, v28
  v_lshl_add_u32 v28, v26, 5, v28
  v_and_b32 v27, 1, v27
  v_xor_b32 v27, 1, v27
  v_lshl_add_u32 v28, v27, 3, v28
  s_lshl_b32 s15, s42, 10
  s_add_u32 s15, s15, 640
  v_add_u32 v242, s15, v28
  s_and_b32 s77, s4, 3
  s_lshl_b32 s77, s77, 13
  s_lshl_b32 s15, s42, 11
  s_add_u32 s77, s77, s15
  s_add_u32 s68, s77, 12582912
  v_lshrrev_b32 v246, 2, v0
  v_lshlrev_b32 v246, 7, v246
  v_and_b32_e64 v27, 3, v0
  v_lshl_add_u32 v246, v27, 2, v246
  v_lshrrev_b32 v247, 1, v0
  v_lshlrev_b32 v27, 4, v247
  v_lshlrev_b32 v247, 13, v247
  v_and_b32 v28, 1, v0
  v_lshl_add_u32 v247, v28, 4, v247
  s_lshl_b32 s77, s42, 19
  s_lshl_b32 s15, s9, 5
  s_add_u32 s77, s77, s15
  s_add_u32 s69, s77, 0
  s_add_u32 s70, s69, 262144
  v_mul_u32_u24 v28, 4608, v28
  s_lshl_b32 s15, s42, 10
  s_add_u32 s15, s15, 640
  v_add3_u32 v248, v28, v27, s15
  s_waitcnt vmcnt(6)
  buffer_load_dword v21, v1, s[72:75], 0 offen sc1
  v_and_b32 v34, 0xffff0000, v4
  v_lshlrev_b32_e64 v32, 16, v4
  v_and_b32 v35, 0xffff0000, v8
  v_lshlrev_b32_e64 v33, 16, v8
  v_and_b32 v38, 0xffff0000, v5
  v_lshlrev_b32_e64 v36, 16, v5
  v_and_b32 v39, 0xffff0000, v9
  v_lshlrev_b32_e64 v37, 16, v9
  v_and_b32 v42, 0xffff0000, v6
  v_lshlrev_b32_e64 v40, 16, v6
  v_and_b32 v43, 0xffff0000, v10
  v_lshlrev_b32_e64 v41, 16, v10
  v_and_b32 v46, 0xffff0000, v7
  v_lshlrev_b32_e64 v44, 16, v7
  v_and_b32 v47, 0xffff0000, v11
  v_lshlrev_b32 v45, 16, v11
  v_readfirstlane_b32 s58, v32
  v_readfirstlane_b32 s59, v33
  s_nop 1
  v_pk_add_f32 v[48:49], v[32:33], s[58:59] neg_lo:[0,1] neg_hi:[0,1]
  v_pk_add_f32 v[50:51], v[34:35], s[58:59] neg_lo:[0,1] neg_hi:[0,1]
  v_pk_add_f32 v[52:53], v[36:37], s[58:59] neg_lo:[0,1] neg_hi:[0,1]
  v_pk_add_f32 v[54:55], v[38:39], s[58:59] neg_lo:[0,1] neg_hi:[0,1]
  v_pk_add_f32 v[56:57], v[40:41], s[58:59] neg_lo:[0,1] neg_hi:[0,1]
  v_pk_add_f32 v[58:59], v[42:43], s[58:59] neg_lo:[0,1] neg_hi:[0,1]
  v_pk_add_f32 v[60:61], v[44:45], s[58:59] neg_lo:[0,1] neg_hi:[0,1]
  v_pk_add_f32 v[62:63], v[46:47], s[58:59] neg_lo:[0,1] neg_hi:[0,1]
  v_pk_mul_f32 v[66:67], v[48:49], v[48:49]
  v_pk_add_f32 v[64:65], v[48:49], v[50:51]
  v_pk_fma_f32 v[66:67], v[50:51], v[50:51], v[66:67]
  v_pk_fma_f32 v[66:67], v[52:53], v[52:53], v[66:67]
  v_pk_add_f32 v[64:65], v[64:65], v[52:53]
  v_pk_fma_f32 v[66:67], v[54:55], v[54:55], v[66:67]
  v_pk_add_f32 v[64:65], v[64:65], v[54:55]
  v_pk_fma_f32 v[66:67], v[56:57], v[56:57], v[66:67]
  v_pk_add_f32 v[64:65], v[64:65], v[56:57]
  v_pk_fma_f32 v[66:67], v[58:59], v[58:59], v[66:67]
  v_pk_add_f32 v[64:65], v[64:65], v[58:59]
  v_pk_fma_f32 v[66:67], v[60:61], v[60:61], v[66:67]
  v_pk_add_f32 v[64:65], v[64:65], v[60:61]
  v_pk_fma_f32 v[66:67], v[62:63], v[62:63], v[66:67]
  v_pk_add_f32 v[64:65], v[64:65], v[62:63]
  s_nop 1
  v_permlane32_swap_b32 v64, v65
  v_permlane32_swap_b32 v66, v67
  v_add_f32 v64, v64, v65
  v_add_f32_e64 v66, v66, v67
  s_nop 1
  v_permlane16_swap_b32 v64, v66
  v_add_f32 v64, v64, v66
  s_nop 1
  v_add_f32_dpp v64, v64, v64 quad_perm:[1,0,3,2] row_mask:0xf bank_mask:0xf
  s_nop 1
  v_add_f32_dpp v64, v64, v64 quad_perm:[2,3,0,1] row_mask:0xf bank_mask:0xf
  s_nop 1
  v_add_f32_dpp v64, v64, v64 row_half_mirror row_mask:0xf bank_mask:0xf
  s_nop 1
  v_add_f32_dpp v64, v64, v64 row_mirror row_mask:0xf bank_mask:0xf
  s_nop 0
  v_readlane_b32 s60, v64, 0
  v_readlane_b32 s61, v64, 32
  v_readlane_b32 s62, v64, 16
  v_readlane_b32 s63, v64, 48
  v_mov_b32 v68, 0x3b000000
  v_pk_mul_f32 v[64:65], s[60:61], v[68:69] op_sel_hi:[1,0]
  v_pk_mul_f32 v[66:67], s[62:63], v[68:69] op_sel_hi:[1,0]
  v_pk_fma_f32 v[66:67], v[64:65], v[64:65], v[66:67] neg_lo:[1,0,0] neg_hi:[1,0,0]
  v_pk_add_f32 v[64:65], v[64:65], s[58:59]
  v_max_f32 v66, 0, v66
  v_max_f32 v67, 0, v67
  v_cvt_pk_bf16_f32 v68, v64, v65
  v_cvt_pk_bf16_f32 v69, v66, v67
  v_and_b32 v65, 0xffff0000, v68
  v_lshlrev_b32_e64 v64, 16, v68
  v_and_b32 v67, 0xffff0000, v69
  v_lshlrev_b32_e64 v66, 16, v69
  v_add_f32 v66, 0x3727c5ac, v66
  v_add_f32 v67, 0x3727c5ac, v67
  v_cvt_pk_bf16_f32 v69, v66, v67
  v_and_b32 v67, 0xffff0000, v69
  v_lshlrev_b32 v66, 16, v69
  v_sqrt_f32 v66, v66
  v_sqrt_f32 v67, v67
  s_nop 0
  v_cvt_pk_bf16_f32 v69, v66, v67
  v_and_b32 v67, 0xffff0000, v69
  v_lshlrev_b32 v66, 16, v69
  v_rcp_f32 v230, v66
  v_rcp_f32_e64 v231, v67
  v_xor_b32 v229, 0x80008000, v68
  v_readfirstlane_b32 s29, v69
  v_readfirstlane_b32 s27, v229
  v_pk_mul_f32 v[64:65], v[64:65], v[230:231]
  v_pk_fma_f32 v[32:33], v[32:33], v[230:231], v[64:65] neg_lo:[0,0,1] neg_hi:[0,0,1]
  v_pk_fma_f32 v[34:35], v[34:35], v[230:231], v[64:65] neg_lo:[0,0,1] neg_hi:[0,0,1]
  v_pk_fma_f32 v[36:37], v[36:37], v[230:231], v[64:65] neg_lo:[0,0,1] neg_hi:[0,0,1]
  v_pk_fma_f32 v[38:39], v[38:39], v[230:231], v[64:65] neg_lo:[0,0,1] neg_hi:[0,0,1]
  v_pk_fma_f32 v[40:41], v[40:41], v[230:231], v[64:65] neg_lo:[0,0,1] neg_hi:[0,0,1]
  v_pk_fma_f32 v[42:43], v[42:43], v[230:231], v[64:65] neg_lo:[0,0,1] neg_hi:[0,0,1]
  v_pk_fma_f32 v[44:45], v[44:45], v[230:231], v[64:65] neg_lo:[0,0,1] neg_hi:[0,0,1]
  v_pk_fma_f32 v[46:47], v[46:47], v[230:231], v[64:65] neg_lo:[0,0,1] neg_hi:[0,0,1]
  v_cvt_pk_bf16_f32 v48, v33, v32
  v_cvt_pk_bf16_f32 v49, v35, v34
  v_cvt_pk_bf16_f32 v50, v37, v36
  v_cvt_pk_bf16_f32 v51, v39, v38
  v_cvt_pk_bf16_f32 v52, v41, v40
  v_cvt_pk_bf16_f32 v53, v43, v42
  v_cvt_pk_bf16_f32 v54, v45, v44
  v_cvt_pk_bf16_f32 v55, v47, v46
  s_sub_u32 s15, 3, s42
  s_lshl_b32 s15, s15, 11
  s_add_u32 s15, s15, 9344
  v_lshl_add_u32 v22, v0, 5, s15
  ds_write_b128 v22, v[48:51]
  ds_write_b128 v22, v[52:55] offset:16
  s_lshl_b32 s15, s42, 3
  v_mov_b32 v23, s15
  v_mov_b32 v68, v229
  s_mov_b64 exec, 1
  ds_write_b64 v23, v[68:69] offset:17536
  ds_add_u32 v1, v2 offset:0
  s_mov_b64 exec, -1
  s_lshl_b32 s15, s42, 8
  s_add_u32 s15, s15, 9344
  v_lshl_add_u32 v22, v0, 2, s15
  s_lshl_b32 s77, s8, 13
  s_lshl_b32 s15, s42, 10
  s_add_u32 s77, s77, s15
  s_add_u32 s77, s77, 0
  s_add_u32 s58, s77, 4096
  s_lshl_b32 s79, s42, 15
  s_lshl_b32 s78, s8, 7
  s_lshl_b32 s15, s42, 4
  s_add_u32 s78, s15, s78
  s_add_u32 s78, s78, 12976128
  s_lshr_b32 s79, s79, 2
  s_lshr_b32 s15, s8, 2
  s_lshl_b32 s15, s15, 7
  s_add_u32 s79, s79, s15
  s_and_b32 s15, s8, 3
  s_lshl_b32 s15, s15, 2
  s_add_u32 s79, s79, s15
  s_add_u32 s79, s79, 12582912
  ds_read_b32 v3, v1 offset:0
  s_waitcnt lgkmcnt(0)
  v_readfirstlane_b32 s15, v3
  s_nop 0
  s_cmp_ge_u32 s15, 4
  s_cbranch_scc1 L_lwd_2
L_lw_1:
  s_sleep 1
  ds_read_b32 v3, v1 offset:0
  s_sub_u32 s76, s76, 1
  s_waitcnt lgkmcnt(0)
  v_readfirstlane_b32 s15, v3
  s_cmp_lt_i32 s76, 0
  s_cselect_b32 s15, 4, s15
  s_cmp_ge_u32 s15, 4
  s_cbranch_scc0 L_lw_1
L_lwd_2:
  ds_read2st64_b32 v[32:33], v22 offset0:0 offset1:8
  ds_read2st64_b32 v[34:35], v22 offset0:16 offset1:24
  ds_read2st64_b32 v[36:37], v22 offset0:4 offset1:12
  ds_read2st64_b32 v[38:39], v22 offset0:20 offset1:28
  s_waitcnt lgkmcnt(2)
  buffer_store_dwordx4 v[32:35], v16, s[44:47], s77 offen sc1
  s_waitcnt lgkmcnt(0)
  buffer_store_dwordx4 v[36:39], v16, s[44:47], s58 offen sc1
  s_cmp_lg_u32 s42, 0
  s_cbranch_scc1 L_nsv
  v_and_b32_e64 v23, 3, v0
  v_lshlrev_b32 v23, 3, v23
  ds_read_b64 v[42:43], v23 offset:17536
  s_waitcnt vmcnt(2)
  v_readfirstlane_b32 s14, v21
  s_nop 0
  s_cmp_lg_u32 s14, 0
  s_cbranch_scc1 L_nwd_4
L_nw_3:
  buffer_load_dword v21, v1, s[72:75], 0 offen sc1
  s_sub_u32 s76, s76, 1
  s_waitcnt vmcnt(0)
  v_readfirstlane_b32 s14, v21
  s_cmp_lt_i32 s76, 0
  s_cselect_b32 s14, 1, s14
  s_cmp_lg_u32 s14, 0
  s_cbranch_scc0 L_nw_3
L_nwd_4:
  s_lshl_b32 s15, s8, 7
  s_add_u32 s15, s15, 12976128
  v_mov_b32 v40, s14
  s_waitcnt lgkmcnt(0)
  v_mov_b32 v41, v42
  v_mov_b32 v42, s14
  s_mov_b64 exec, 0xff
  buffer_store_dwordx4 v[40:43], v16, s[44:47], s15 offen sc1
  s_mov_b64 exec, -1
L_nsv:
  s_mov_b64 exec, 1
  ds_add_u32 v1, v2 offset:64
  s_mov_b64 exec, -1
  s_waitcnt vmcnt(2)
  s_setprio 0
  s_mov_b32 s60, 0x3fb8aa3b
  s_lshr_b32 s15, s42, 1
  s_lshl_b32 s15, s15, 4
  v_lshrrev_b32 v216, s15, v216
  v_lshlrev_b32 v216, 16, v216
  v_lshlrev_b32 v212, 16, v212
  v_lshlrev_b32_e64 v213, 16, v213
  v_mul_f32 v29, 0x3fb8aa3b, v216
  v_fma_f32 v30, v216, s60, -v29
  v_fmac_f32 v30, 0x32a5705f, v216
  v_exp_f32_e64 v28, v29
  v_mul_f32 v30, 0x3f317218, v30
  v_fmac_f32_e64 v28, v28, v30
  v_cvt_pk_bf16_f32 v28, v28, v28
  v_lshlrev_b32_e64 v28, 16, v28
  v_mul_f32 v29, 0x3fb8aa3b, v212
  v_fma_f32 v30, v212, s60, -v29
  v_fmac_f32 v30, 0x32a5705f, v212
  v_exp_f32_e64 v31, v29
  v_mul_f32 v30, 0x3f317218, v30
  v_fmac_f32_e64 v31, v31, v30
  v_cvt_pk_bf16_f32 v31, v31, v31
  v_lshlrev_b32 v31, 16, v31
  v_mul_f32 v212, v31, v28
  v_mul_f32_e64 v213, v213, v28
  v_mul_f32 v212, 0xbfb8aa3b, v212
  v_mul_f32 v213, 0x3e22f983, v213
  v_lshlrev_b32 v214, 16, v214
  v_lshlrev_b32 v215, 16, v215
  v_mul_f32 v214, v214, v28
  v_mul_f32 v215, v215, v28
  v_add_f32 v214, v214, v214
  v_add_f32 v215, v215, v215
  v_mul_f32 v62, 0x3f800000, v212
  v_mul_f32 v63, 0xbf800000, v213
  v_exp_f32 v62, v62
  v_fract_f32 v63, v63
  v_cos_f32 v54, v63
  v_sin_f32_e64 v55, v63
  v_mul_f32 v96, 0x43800000, v212
  v_mul_f32 v97, 0xc3800000, v213
  v_exp_f32 v96, v96
  v_fract_f32 v97, v97
  v_cos_f32 v82, v97
  v_sin_f32 v83, v97
  v_pk_mul_f32 v[54:55], v[54:55], v[62:63] op_sel_hi:[1,0]
  v_pk_mul_f32 v[82:83], v[82:83], v[96:97] op_sel_hi:[1,0]
  v_mov_b32 v56, v55
  v_mov_b32 v58, v83
  v_mov_b32_e64 v64, v214
  v_xor_b32 v65, 0x80000000, v215
  v_pk_mul_f32 v[66:67], v[64:65], v[54:55] op_sel_hi:[1,0]
  v_pk_mul_f32 v[84:85], v[82:83], v[82:83] op_sel_hi:[1,0]
  v_pk_fma_f32 v[66:67], v[64:65], v[56:57], v[66:67] op_sel:[1,0,0] op_sel_hi:[0,0,1] neg_lo:[1,0,0]
  v_pk_fma_f32 v[84:85], v[82:83], v[58:59], v[84:85] op_sel:[1,0,0] op_sel_hi:[0,0,1] neg_lo:[1,0,0]
  v_pk_mul_f32 v[68:69], v[66:67], v[54:55] op_sel_hi:[1,0]
  v_pk_mul_f32 v[86:87], v[84:85], v[82:83] op_sel_hi:[1,0]
  v_pk_fma_f32 v[68:69], v[66:67], v[56:57], v[68:69] op_sel:[1,0,0] op_sel_hi:[0,0,1] neg_lo:[1,0,0]
  v_pk_fma_f32 v[86:87], v[84:85], v[58:59], v[86:87] op_sel:[1,0,0] op_sel_hi:[0,0,1] neg_lo:[1,0,0]
  v_pk_mul_f32 v[70:71], v[68:69], v[54:55] op_sel_hi:[1,0]
  v_pk_mul_f32 v[88:89], v[86:87], v[82:83] op_sel_hi:[1,0]
  v_pk_fma_f32 v[70:71], v[68:69], v[56:57], v[70:71] op_sel:[1,0,0] op_sel_hi:[0,0,1] neg_lo:[1,0,0]
  v_pk_fma_f32 v[88:89], v[86:87], v[58:59], v[88:89] op_sel:[1,0,0] op_sel_hi:[0,0,1] neg_lo:[1,0,0]
  v_pk_mul_f32 v[72:73], v[70:71], v[54:55] op_sel_hi:[1,0]
  v_pk_mul_f32 v[90:91], v[88:89], v[82:83] op_sel_hi:[1,0]
  v_pk_fma_f32 v[72:73], v[70:71], v[56:57], v[72:73] op_sel:[1,0,0] op_sel_hi:[0,0,1] neg_lo:[1,0,0]
  v_pk_fma_f32 v[90:91], v[88:89], v[58:59], v[90:91] op_sel:[1,0,0] op_sel_hi:[0,0,1] neg_lo:[1,0,0]
  v_pk_mul_f32 v[74:75], v[72:73], v[54:55] op_sel_hi:[1,0]
  v_pk_mul_f32 v[92:93], v[90:91], v[82:83] op_sel_hi:[1,0]
  v_pk_fma_f32 v[74:75], v[72:73], v[56:57], v[74:75] op_sel:[1,0,0] op_sel_hi:[0,0,1] neg_lo:[1,0,0]
  v_pk_fma_f32 v[92:93], v[90:91], v[58:59], v[92:93] op_sel:[1,0,0] op_sel_hi:[0,0,1] neg_lo:[1,0,0]
  v_pk_mul_f32 v[76:77], v[74:75], v[54:55] op_sel_hi:[1,0]
  v_pk_mul_f32 v[94:95], v[92:93], v[82:83] op_sel_hi:[1,0]
  v_pk_fma_f32 v[76:77], v[74:75], v[56:57], v[76:77] op_sel:[1,0,0] op_sel_hi:[0,0,1] neg_lo:[1,0,0]
  v_pk_fma_f32 v[94:95], v[92:93], v[58:59], v[94:95] op_sel:[1,0,0] op_sel_hi:[0,0,1] neg_lo:[1,0,0]
  v_pk_mul_f32 v[78:79], v[76:77], v[54:55] op_sel_hi:[1,0]
  v_pk_fma_f32 v[78:79], v[76:77], v[56:57], v[78:79] op_sel:[1,0,0] op_sel_hi:[0,0,1] neg_lo:[1,0,0]
  v_pk_mul_f32 v[80:81], v[78:79], v[54:55] op_sel_hi:[1,0]
  v_pk_fma_f32 v[80:81], v[78:79], v[56:57], v[80:81] op_sel:[1,0,0] op_sel_hi:[0,0,1] neg_lo:[1,0,0]
  v_mov_b32 v96, v65
  v_mov_b32 v98, v69
  v_mov_b32 v100, v73
  v_mov_b32 v102, v77
  v_mov_b32_e64 v104, v81
  v_pk_mul_f32 v[106:107], v[82:83], v[64:65] op_sel_hi:[1,0]
  v_pk_mul_f32 v[108:109], v[82:83], v[68:69] op_sel_hi:[1,0]
  v_pk_mul_f32 v[110:111], v[82:83], v[72:73] op_sel_hi:[1,0]
  v_pk_mul_f32 v[112:113], v[82:83], v[76:77] op_sel_hi:[1,0]
  v_pk_mul_f32 v[114:115], v[82:83], v[80:81] op_sel_hi:[1,0]
  v_pk_fma_f32 v[106:107], v[82:83], v[96:97], v[106:107] op_sel:[1,0,0] op_sel_hi:[0,0,1] neg_lo:[1,0,0]
  v_pk_fma_f32 v[108:109], v[82:83], v[98:99], v[108:109] op_sel:[1,0,0] op_sel_hi:[0,0,1] neg_lo:[1,0,0]
  v_pk_fma_f32 v[110:111], v[82:83], v[100:101], v[110:111] op_sel:[1,0,0] op_sel_hi:[0,0,1] neg_lo:[1,0,0]
  v_pk_fma_f32 v[112:113], v[82:83], v[102:103], v[112:113] op_sel:[1,0,0] op_sel_hi:[0,0,1] neg_lo:[1,0,0]
  v_pk_fma_f32 v[114:115], v[82:83], v[104:105], v[114:115] op_sel:[1,0,0] op_sel_hi:[0,0,1] neg_lo:[1,0,0]
  v_cvt_pk_bf16_f32 v168, v64, v66
  v_cvt_pk_bf16_f32 v184, v65, v67
  v_cvt_pk_bf16_f32 v169, v68, v70
  v_cvt_pk_bf16_f32 v185, v69, v71
  v_cvt_pk_bf16_f32 v170, v72, v74
  v_cvt_pk_bf16_f32 v186, v73, v75
  v_cvt_pk_bf16_f32 v171, v76, v78
  v_cvt_pk_bf16_f32 v187, v77, v79
  v_cvt_pk_bf16_f32 v172, v72, v106
  v_cvt_pk_bf16_f32 v188, v73, v107
  v_cvt_pk_bf16_f32 v173, v108, v110
  v_cvt_pk_bf16_f32 v189, v109, v111
  v_cvt_pk_bf16_f32 v174, v80, v110
  v_cvt_pk_bf16_f32 v190, v81, v111
  v_cvt_pk_bf16_f32 v175, v112, v114
  v_cvt_pk_bf16_f32 v191, v113, v115
  v_pk_mul_f32 v[106:107], v[84:85], v[64:65] op_sel_hi:[1,0]
  v_pk_mul_f32 v[108:109], v[84:85], v[72:73] op_sel_hi:[1,0]
  v_pk_mul_f32 v[110:111], v[84:85], v[80:81] op_sel_hi:[1,0]
  v_pk_mul_f32 v[112:113], v[88:89], v[64:65] op_sel_hi:[1,0]
  v_pk_mul_f32 v[114:115], v[86:87], v[64:65] op_sel_hi:[1,0]
  v_pk_mul_f32 v[116:117], v[86:87], v[72:73] op_sel_hi:[1,0]
  v_pk_mul_f32 v[118:119], v[86:87], v[80:81] op_sel_hi:[1,0]
  v_pk_mul_f32 v[120:121], v[92:93], v[64:65] op_sel_hi:[1,0]
  v_pk_fma_f32 v[106:107], v[84:85], v[96:97], v[106:107] op_sel:[1,0,0] op_sel_hi:[0,0,1] neg_lo:[1,0,0]
  v_pk_fma_f32 v[108:109], v[84:85], v[100:101], v[108:109] op_sel:[1,0,0] op_sel_hi:[0,0,1] neg_lo:[1,0,0]
  v_pk_fma_f32 v[110:111], v[84:85], v[104:105], v[110:111] op_sel:[1,0,0] op_sel_hi:[0,0,1] neg_lo:[1,0,0]
  v_pk_fma_f32 v[112:113], v[88:89], v[96:97], v[112:113] op_sel:[1,0,0] op_sel_hi:[0,0,1] neg_lo:[1,0,0]
  v_pk_fma_f32 v[114:115], v[86:87], v[96:97], v[114:115] op_sel:[1,0,0] op_sel_hi:[0,0,1] neg_lo:[1,0,0]
  v_pk_fma_f32 v[116:117], v[86:87], v[100:101], v[116:117] op_sel:[1,0,0] op_sel_hi:[0,0,1] neg_lo:[1,0,0]
  v_pk_fma_f32 v[118:119], v[86:87], v[104:105], v[118:119] op_sel:[1,0,0] op_sel_hi:[0,0,1] neg_lo:[1,0,0]
  v_pk_fma_f32 v[120:121], v[92:93], v[96:97], v[120:121] op_sel:[1,0,0] op_sel_hi:[0,0,1] neg_lo:[1,0,0]
  v_cvt_pk_bf16_f32 v176, v106, v108
  v_cvt_pk_bf16_f32 v192, v107, v109
  v_cvt_pk_bf16_f32 v177, v110, v112
  v_cvt_pk_bf16_f32 v193, v111, v113
  v_cvt_pk_bf16_f32 v178, v114, v116
  v_cvt_pk_bf16_f32 v194, v115, v117
  v_cvt_pk_bf16_f32 v179, v118, v120
  v_cvt_pk_bf16_f32 v195, v119, v121
  v_pk_mul_f32 v[106:107], v[88:89], v[80:81] op_sel_hi:[1,0]
  v_pk_mul_f32 v[108:109], v[90:91], v[64:65] op_sel_hi:[1,0]
  v_pk_mul_f32 v[110:111], v[90:91], v[80:81] op_sel_hi:[1,0]
  v_pk_mul_f32 v[112:113], v[92:93], v[80:81] op_sel_hi:[1,0]
  v_pk_mul_f32 v[114:115], v[94:95], v[64:65] op_sel_hi:[1,0]
  v_pk_mul_f32 v[116:117], v[94:95], v[80:81] op_sel_hi:[1,0]
  v_pk_fma_f32 v[106:107], v[88:89], v[104:105], v[106:107] op_sel:[1,0,0] op_sel_hi:[0,0,1] neg_lo:[1,0,0]
  v_pk_fma_f32 v[108:109], v[90:91], v[96:97], v[108:109] op_sel:[1,0,0] op_sel_hi:[0,0,1] neg_lo:[1,0,0]
  v_pk_fma_f32 v[110:111], v[90:91], v[104:105], v[110:111] op_sel:[1,0,0] op_sel_hi:[0,0,1] neg_lo:[1,0,0]
  v_pk_fma_f32 v[112:113], v[92:93], v[104:105], v[112:113] op_sel:[1,0,0] op_sel_hi:[0,0,1] neg_lo:[1,0,0]
  v_pk_fma_f32 v[114:115], v[94:95], v[96:97], v[114:115] op_sel:[1,0,0] op_sel_hi:[0,0,1] neg_lo:[1,0,0]
  v_pk_fma_f32 v[116:117], v[94:95], v[104:105], v[116:117] op_sel:[1,0,0] op_sel_hi:[0,0,1] neg_lo:[1,0,0]
  v_cvt_pk_bf16_f32 v180, v106, v108
  v_cvt_pk_bf16_f32 v196, v107, v109
  v_cvt_pk_bf16_f32 v181, v110, v110
  v_cvt_pk_bf16_f32 v197, v111, v111
  v_cvt_pk_bf16_f32 v182, v112, v114
  v_cvt_pk_bf16_f32 v198, v113, v115
  v_cvt_pk_bf16_f32 v183, v116, v116
  v_cvt_pk_bf16_f32 v199, v117, v117
  s_setprio 3
  ds_read_b32 v3, v210 offset:68
  s_waitcnt lgkmcnt(0)
  v_readfirstlane_b32 s15, v3
  s_nop 0
  s_cmp_ge_u32 s15, 1
  s_cbranch_scc1 L_lwd_6
L_lw_5:
  s_sleep 1
  ds_read_b32 v3, v210 offset:68
  s_sub_u32 s76, s76, 1
  s_waitcnt lgkmcnt(0)
  v_readfirstlane_b32 s15, v3
  s_cmp_lt_i32 s76, 0
  s_cselect_b32 s15, 1, s15
  s_cmp_ge_u32 s15, 1
  s_cbranch_scc0 L_lw_5
L_lwd_6:
  ds_read_b64_tr_b16 v[32:33], v208 offset:0
  ds_read_b64_tr_b16 v[34:35], v209 offset:0
  ds_read_b64_tr_b16 v[36:37], v208 offset:1024
  ds_read_b64_tr_b16 v[38:39], v209 offset:1024
  ds_read_b64_tr_b16 v[40:41], v208 offset:2048
  ds_read_b64_tr_b16 v[42:43], v209 offset:2048
  ds_read_b64_tr_b16 v[44:45], v208 offset:3072
  ds_read_b64_tr_b16 v[46:47], v209 offset:3072
  ds_read_b64_tr_b16 v[48:49], v208 offset:4096
  ds_read_b64_tr_b16 v[50:51], v209 offset:4096
  ds_read_b64_tr_b16 v[52:53], v208 offset:5120
  ds_read_b64_tr_b16 v[54:55], v209 offset:5120
  ds_read_b64_tr_b16 v[56:57], v208 offset:6144
  ds_read_b64_tr_b16 v[58:59], v209 offset:6144
  ds_read_b64_tr_b16 v[60:61], v208 offset:7168
  ds_read_b64_tr_b16 v[62:63], v209 offset:7168
  ds_write_b128 v200, v[168:171]
  ds_write_b128 v201, v[172:175]
  ds_write_b128 v202, v[176:179]
  ds_write_b128 v203, v[180:183]
  ds_write_b128 v204, v[184:187]
  ds_write_b128 v205, v[188:191]
  ds_write_b128 v206, v[192:195]
  ds_write_b128 v207, v[196:199]
  ds_read_b64_tr_b16 v[64:65], v208 offset:0
  ds_read_b64_tr_b16 v[66:67], v209 offset:0
  ds_read_b64_tr_b16 v[68:69], v208 offset:1024
  ds_read_b64_tr_b16 v[70:71], v209 offset:1024
  ds_read_b64_tr_b16 v[72:73], v208 offset:2048
  ds_read_b64_tr_b16 v[74:75], v209 offset:2048
  ds_read_b64_tr_b16 v[76:77], v208 offset:3072
  ds_read_b64_tr_b16 v[78:79], v209 offset:3072
  ds_read_b64_tr_b16 v[80:81], v208 offset:4096
  ds_read_b64_tr_b16 v[82:83], v209 offset:4096
  ds_read_b64_tr_b16 v[84:85], v208 offset:5120
  ds_read_b64_tr_b16 v[86:87], v209 offset:5120
  ds_read_b64_tr_b16 v[88:89], v208 offset:6144
  ds_read_b64_tr_b16 v[90:91], v209 offset:6144
  ds_read_b64_tr_b16 v[92:93], v208 offset:7168
  ds_read_b64_tr_b16 v[94:95], v209 offset:7168
  s_waitcnt lgkmcnt(0)
  s_setprio 3
  v_mfma_f32_32x32x16_bf16 v[112:127], v[64:67], v[32:35], 0
  v_mfma_f32_32x32x16_bf16 v[112:127], v[68:71], v[36:39], v[112:127]
  v_mfma_f32_32x32x16_bf16 v[112:127], v[72:75], v[40:43], v[112:127]
  v_mfma_f32_32x32x16_bf16 v[112:127], v[76:79], v[44:47], v[112:127]
  v_mfma_f32_32x32x16_bf16 v[112:127], v[80:83], v[48:51], v[112:127]
  v_mfma_f32_32x32x16_bf16 v[112:127], v[84:87], v[52:55], v[112:127]
  v_mfma_f32_32x32x16_bf16 v[112:127], v[88:91], v[56:59], v[112:127]
  v_mfma_f32_32x32x16_bf16 v[112:127], v[92:95], v[60:63], v[112:127]
  s_nop 11
  ds_write_b128 v243, v[112:115] offset:0
  ds_write_b128 v243, v[116:119] offset:1024
  ds_write_b128 v243, v[120:123] offset:2048
  ds_write_b128 v243, v[124:127] offset:3072
  s_mov_b64 exec, 1
  ds_add_u32 v245, v2 offset:4
  s_mov_b64 exec, -1
  s_waitcnt vmcnt(0)
  v_readfirstlane_b32 s14, v21
  s_nop 0
  s_cmp_lg_u32 s14, 0
  s_cbranch_scc1 L_nwd_8
L_nw_7:
  buffer_load_dword v21, v1, s[72:75], 0 offen sc1
  s_sub_u32 s76, s76, 1
  s_waitcnt vmcnt(0)
  v_readfirstlane_b32 s14, v21
  s_cmp_lt_i32 s76, 0
  s_cselect_b32 s14, 1, s14
  s_cmp_lg_u32 s14, 0
  s_cbranch_scc0 L_nw_7
L_nwd_8:
  s_mov_b32 s30, s14
  s_atomic_swap s30, s[40:41], s79
  s_setprio 0
  ds_read_b32 v3, v245 offset:4
  s_waitcnt lgkmcnt(0)
  v_readfirstlane_b32 s15, v3
  s_nop 0
  s_cmp_ge_u32 s15, 2
  s_cbranch_scc1 L_lwd_10
L_lw_9:
  s_sleep 1
  ds_read_b32 v3, v245 offset:4
  s_sub_u32 s76, s76, 1
  s_waitcnt lgkmcnt(0)
  v_readfirstlane_b32 s15, v3
  s_cmp_lt_i32 s76, 0
  s_cselect_b32 s15, 2, s15
  s_cmp_ge_u32 s15, 2
  s_cbranch_scc0 L_lw_9
L_lwd_10:
  ds_read_b128 v[32:35], v244 offset:0
  ds_read_b128 v[36:39], v244 offset:1024
  ds_read_b128 v[40:43], v244 offset:2048
  ds_read_b128 v[44:47], v244 offset:3072
  s_mov_b64 exec, 1
  ds_add_u32 v1, v2 offset:20
  s_mov_b64 exec, -1
  ds_read_b32 v3, v1 offset:64
  s_waitcnt lgkmcnt(0)
  v_readfirstlane_b32 s15, v3
  s_nop 0
  s_cmp_ge_u32 s15, 4
  s_cbranch_scc1 L_lwd_12
L_lw_11:
  s_sleep 1
  ds_read_b32 v3, v1 offset:64
  s_sub_u32 s76, s76, 1
  s_waitcnt lgkmcnt(0)
  v_readfirstlane_b32 s15, v3
  s_cmp_lt_i32 s76, 0
  s_cselect_b32 s15, 4, s15
  s_cmp_ge_u32 s15, 4
  s_cbranch_scc0 L_lw_11
L_lwd_12:
  v_and_b32 v28, 1, v0
  v_cmp_eq_u32 vcc, 0, v28
  s_waitcnt lgkmcnt(0)
  v_add_f32 v112, v112, v32
  v_add_f32 v113, v113, v33
  v_add_f32 v114, v114, v34
  v_add_f32 v115, v115, v35
  v_add_f32 v116, v116, v36
  v_add_f32 v117, v117, v37
  v_add_f32 v118, v118, v38
  v_add_f32 v119, v119, v39
  v_add_f32 v120, v120, v40
  v_add_f32 v121, v121, v41
  v_add_f32 v122, v122, v42
  v_add_f32 v123, v123, v43
  v_add_f32 v124, v124, v44
  v_add_f32 v125, v125, v45
  v_add_f32 v126, v126, v46
  v_add_f32 v127, v127, v47
  v_cndmask_b32 v48, v124, v123, vcc
  v_cndmask_b32 v49, v126, v125, vcc
  s_cmp_eq_u32 s99, 1
  s_cbranch_scc1 L_odd
  v_cvt_pk_bf16_f32 v32, v112, v113
  v_cvt_pk_bf16_f32 v33, v114, v115
  v_cvt_pk_bf16_f32 v34, v117, v117
  v_cvt_pk_bf16_f32 v35, v118, v119
  v_cvt_pk_bf16_f32 v36, v120, v120
  v_cvt_pk_bf16_f32 v37, v120, v121
  v_cvt_pk_bf16_f32 v38, v121, v121
  v_cvt_pk_bf16_f32 v39, v122, v122
  v_cvt_pk_bf16_f32 v40, v123, v123
  v_cvt_pk_bf16_f32 v41, v123, v123
  v_cvt_pk_bf16_f32 v42, v48, v124
  v_cvt_pk_bf16_f32 v43, v124, v124
  v_cvt_pk_bf16_f32 v44, v125, v125
  v_cvt_pk_bf16_f32 v45, v125, v125
  v_cvt_pk_bf16_f32 v46, v49, v126
  v_cvt_pk_bf16_f32 v47, v126, v126
  v_mov_b32 v50, 0
  s_branch L_evdone
L_odd:
  v_cvt_pk_bf16_f32 v32, v113, v114
  v_cvt_pk_bf16_f32 v33, v115, v116
  v_cvt_pk_bf16_f32 v34, v117, v118
  v_cvt_pk_bf16_f32 v35, v119, v119
  v_cvt_pk_bf16_f32 v36, v120, v120
  v_cvt_pk_bf16_f32 v37, v121, v121
  v_cvt_pk_bf16_f32 v38, v121, v122
  v_cvt_pk_bf16_f32 v39, v122, v122
  v_cvt_pk_bf16_f32 v40, v123, v123
  v_cvt_pk_bf16_f32 v41, v123, v48
  v_cvt_pk_bf16_f32 v42, v124, v124
  v_cvt_pk_bf16_f32 v43, v124, v124
  v_cvt_pk_bf16_f32 v44, v125, v125
  v_cvt_pk_bf16_f32 v45, v125, v49
  v_cvt_pk_bf16_f32 v46, v126, v126
  v_cvt_pk_bf16_f32 v47, v126, v126
  v_cvt_pk_bf16_f32 v51, v1, v112
  v_mov_b32_e64 v50, 0
  v_readlane_b32 s15, v51, 0
  s_nop 1
  v_writelane_b32 v50, s15, 7
L_evdone:
  ds_write_b64 v232, v[32:33]
  ds_write_b64 v232, v[34:35] offset:512
  ds_write_b128 v233, v[36:39] offset:1024
  ds_write_b128 v234, v[40:43] offset:2048
  ds_write_b128 v234, v[44:47] offset:2560
  s_mov_b64 exec, 0xff
  ds_write_b32 v235, v50
  s_mov_b64 exec, -1
  s_setprio 3
  ds_read_b32 v3, v1 offset:20
  s_waitcnt lgkmcnt(0)
  v_readfirstlane_b32 s15, v3
  s_nop 0
  s_cmp_ge_u32 s15, 4
  s_cbranch_scc1 L_lwd_14
L_lw_13:
  s_sleep 1
  ds_read_b32 v3, v1 offset:20
  s_sub_u32 s76, s76, 1
  s_waitcnt lgkmcnt(0)
  v_readfirstlane_b32 s15, v3
  s_cmp_lt_i32 s76, 0
  s_cselect_b32 s15, 4, s15
  s_cmp_ge_u32 s15, 4
  s_cbranch_scc0 L_lw_13
L_lwd_14:
  s_setprio 1
L_Sw2:
  ds_read_b32 v3, v1 offset:52
  s_waitcnt lgkmcnt(0)
  v_readfirstlane_b32 s15, v3
  s_nop 0
  s_cmp_ge_u32 s15, 4
  s_cbranch_scc1 L_lwd_16
L_lw_15:
  s_sleep 1
  ds_read_b32 v3, v1 offset:52
  s_sub_u32 s76, s76, 1
  s_waitcnt lgkmcnt(0)
  v_readfirstlane_b32 s15, v3
  s_cmp_lt_i32 s76, 0
  s_cselect_b32 s15, 4, s15
  s_cmp_ge_u32 s15, 4
  s_cbranch_scc0 L_lw_15
L_lwd_16:
  buffer_load_dword v31, v246, s[44:47], s68 offen sc1
  s_add_u32 m0, s90, 0
  s_add_u32 s77, s88, 0
  buffer_load_dwordx4 v220, s[64:67], s77 offen lds
  buffer_load_dwordx4 v221, s[64:67], s77 offen offset:1024 lds
  s_add_u32 m0, s90, 8192
  s_add_u32 s77, s88, 16384
  buffer_load_dwordx4 v220, s[64:67], s77 offen lds
  buffer_load_dwordx4 v221, s[64:67], s77 offen offset:1024 lds
  s_add_u32 m0, s90, 16384
  s_add_u32 s77, s88, 32768
  buffer_load_dwordx4 v220, s[64:67], s77 offen lds
  buffer_load_dwordx4 v221, s[64:67], s77 offen offset:1024 lds
  s_add_u32 m0, s90, 24576
  s_add_u32 s77, s88, 49152
  buffer_load_dwordx4 v220, s[64:67], s77 offen lds
  buffer_load_dwordx4 v221, s[64:67], s77 offen offset:1024 lds
  s_add_u32 m0, s90, 32768
  s_add_u32 s77, s88, 65536
  buffer_load_dwordx4 v220, s[64:67], s77 offen lds
  buffer_load_dwordx4 v221, s[64:67], s77 offen offset:1024 lds
  s_add_u32 m0, s90, 40960
  s_add_u32 s77, s88, 81920
  buffer_load_dwordx4 v220, s[64:67], s77 offen lds
  buffer_load_dwordx4 v221, s[64:67], s77 offen offset:1024 lds
  s_mul_i32 s15, s42, 6144
  s_add_u32 s15, s15, 25984
  v_add_u32_e64 v4, s15, v16
  s_lshl_b32 s52, s9, 13
  s_lshl_b32 s15, s42, 11
  s_add_u32 s52, s52, s15
  s_add_u32 s52, s52, 10485760
  s_lshl_b32 s53, s42, 12
  s_lshr_b32 s15, s9, 4
  s_lshl_b32 s15, s15, 8
  s_add_u32 s53, s53, s15
  s_and_b32 s15, s9, 15
  s_lshl_b32 s15, s15, 2
  s_add_u32 s53, s53, s15
  s_add_u32 s53, s53, 12730368
  s_add_u32 s61, s53, 128
  v_lshrrev_b32 v5, 2, v0
  v_lshlrev_b32 v5, 10, v5
  v_and_b32 v26, 3, v0
  v_lshl_add_u32 v5, v26, 4, v5
  v_add_u32 v9, 15360, v5
  s_lshl_b32 s86, s84, 15
  s_lshl_b32 s15, s11, 7
  s_add_u32 s86, s86, s15
  s_lshl_b32 s15, s85, 6
  s_add_u32 s86, s86, s15
  s_mul_i32 s87, s42, 6144
  s_add_u32 s87, s87, 25984
  v_and_b32 v26, 31, v0
  v_lshlrev_b32 v6, 6, v26
  v_lshrrev_b32_e64 v27, 5, v0
  v_lshl_add_u32 v6, v27, 5, v6
  v_add_u32 v6, s87, v6
  v_lshlrev_b32 v26, 2, v26
  v_lshl_add_u32 v7, v27, 16, v26
  v_and_b32 v26, 7, v0
  v_lshlrev_b32 v8, 2, v27
  v_xor_b32 v8, v8, v26
  v_lshlrev_b32 v8, 4, v8
  v_and_b32_e64 v26, 31, v0
  v_lshl_add_u32 v8, v26, 8, v8
  s_and_b32 s15, s84, 1
  s_lshl_b32 s15, s15, 13
  s_lshl_b32 s63, s85, 7
  s_add_u32 s15, s15, s63
  s_add_u32 s15, s15, 9344
  v_add_u32 v8, s15, v8
  v_xor_b32 v17, 16, v8
  v_xor_b32 v18, 32, v8
  v_xor_b32 v19, 48, v8
  s_lshr_b32 s15, s10, 3
  s_lshl_b32 s54, s15, 12
  s_lshl_b32 s15, s11, 9
  s_add_u32 s54, s54, s15
  s_lshl_b32 s15, s85, 8
  s_add_u32 s54, s54, s15
  s_and_b32 s15, s84, 1
  s_lshl_b32 s15, s15, 7
  s_add_u32 s54, s54, s15
  s_add_u32 s54, s54, 12730368
  s_lshl_b32 s55, s11, 18
  s_lshl_b32 s15, s85, 17
  s_add_u32 s55, s55, s15
  s_lshl_b32 s15, s84, 7
  s_add_u32 s55, s55, s15
  s_add_u32 s55, s55, 10485760
  v_bfe_u32 v26, v0, 1, 2
  v_lshlrev_b32 v10, 4, v26
  v_bfe_u32 v26, v0, 3, 2
  v_lshl_add_u32 v10, v26, 7, v10
  s_lshl_b32 s62, s84, 9
  s_add_u32 s62, s62, 12976128
  s_and_b32 s15, s84, 1
  s_lshl_b32 s15, s15, 7
  s_add_u32 s15, s15, 128
  v_and_b32 v26, 31, v0
  v_lshl_add_u32 v11, v26, 2, s15
  ds_read_b32 v3, v1 offset:56
  s_waitcnt lgkmcnt(0)
  v_readfirstlane_b32 s15, v3
  s_nop 0
  s_cmp_ge_u32 s15, 4
  s_cbranch_scc1 L_lwd_18
L_lw_17:
  s_sleep 1
  ds_read_b32 v3, v1 offset:56
  s_sub_u32 s76, s76, 1
  s_waitcnt lgkmcnt(0)
  v_readfirstlane_b32 s15, v3
  s_cmp_lt_i32 s76, 0
  s_cselect_b32 s15, 4, s15
  s_cmp_ge_u32 s15, 4
  s_cbranch_scc0 L_lw_17
L_lwd_18:
  s_add_u32 m0, s90, 49152
  s_add_u32 s77, s88, 98304
  buffer_load_dwordx4 v220, s[64:67], s77 offen lds
  buffer_load_dwordx4 v221, s[64:67], s77 offen offset:1024 lds
  s_waitcnt vmcnt(14)
  v_cmp_ne_u32 vcc, s14, v31
  s_cbranch_vccz L_pd_20
  s_mov_b64 exec, vcc
L_p_19:
  s_sleep 4
  buffer_load_dword v31, v246, s[44:47], s68 offen sc1
  s_sub_u32 s76, s76, 1
  s_waitcnt vmcnt(0)
  v_cmp_ne_u32 vcc, s14, v31
  s_cmp_gt_i32 s76, 0
  s_cselect_b64 exec, vcc, 0
  s_cbranch_execnz L_p_19
L_pd_20:
  s_mov_b64 exec, -1
  buffer_load_dwordx4 v[52:55], v247, s[44:47], s69 offen sc1
  buffer_load_dwordx4 v[56:59], v247, s[44:47], s70 offen sc1
  ds_read_b32 v3, v1 offset:60
  s_waitcnt lgkmcnt(0)
  v_readfirstlane_b32 s15, v3
  s_nop 0
  s_cmp_ge_u32 s15, 4
  s_cbranch_scc1 L_lwd_22
L_lw_21:
  s_sleep 1
  ds_read_b32 v3, v1 offset:60
  s_sub_u32 s76, s76, 1
  s_waitcnt lgkmcnt(0)
  v_readfirstlane_b32 s15, v3
  s_cmp_lt_i32 s76, 0
  s_cselect_b32 s15, 4, s15
  s_cmp_ge_u32 s15, 4
  s_cbranch_scc0 L_lw_21
L_lwd_22:
  s_add_u32 m0, s90, 57344
  s_add_u32 s77, s88, 114688
  buffer_load_dwordx4 v220, s[64:67], s77 offen lds
  buffer_load_dwordx4 v221, s[64:67], s77 offen offset:1024 lds
  s_add_u32 m0, s90, 65536
  s_add_u32 s77, s88, 131072
  buffer_load_dwordx4 v220, s[64:67], s77 offen lds
  buffer_load_dwordx4 v221, s[64:67], s77 offen offset:1024 lds
  s_waitcnt vmcnt(5)
  ds_write_b128 v248, v[52:55]
  s_waitcnt vmcnt(4)
  ds_write_b128 v248, v[56:59] offset:512
  s_mov_b64 exec, 1
  ds_add_u32 v1, v2 offset:12
  s_mov_b64 exec, -1
  ds_read_b32 v3, v1 offset:24
  s_waitcnt lgkmcnt(0)
  v_readfirstlane_b32 s15, v3
  s_nop 0
  s_cmp_ge_u32 s15, 4
  s_cbranch_scc1 L_lwd_24
L_lw_23:
  s_sleep 1
  ds_read_b32 v3, v1 offset:24
  s_sub_u32 s76, s76, 1
  s_waitcnt lgkmcnt(0)
  v_readfirstlane_b32 s15, v3
  s_cmp_lt_i32 s76, 0
  s_cselect_b32 s15, 4, s15
  s_cmp_ge_u32 s15, 4
  s_cbranch_scc0 L_lw_23
L_lwd_24:
  ds_read_b32 v3, v1 offset:12
  s_waitcnt lgkmcnt(0)
  v_readfirstlane_b32 s15, v3
  s_nop 0
  s_cmp_ge_u32 s15, 4
  s_cbranch_scc1 L_lwd_26
L_lw_25:
  s_sleep 1
  ds_read_b32 v3, v1 offset:12
  s_sub_u32 s76, s76, 1
  s_waitcnt lgkmcnt(0)
  v_readfirstlane_b32 s15, v3
  s_cmp_lt_i32 s76, 0
  s_cselect_b32 s15, 4, s15
  s_cmp_ge_u32 s15, 4
  s_cbranch_scc0 L_lw_25
L_lwd_26:
  s_waitcnt vmcnt(0)
  s_mov_b64 exec, 1
  ds_add_u32 v1, v2 offset:84
  s_mov_b64 exec, -1
  ds_read_b64 v[208:209], v242 offset:0
  ds_read_b64 v[210:211], v242 offset:512
  ds_read_b64 v[212:213], v242 offset:4608
  ds_read_b64 v[214:215], v242 offset:5120
  ds_read_b128 v[64:67], v240 offset:192
  ds_read2_b32 v[32:33], v236 offset0:0 offset1:1
  ds_read2_b32 v[34:35], v236 offset0:2 offset1:3
  ds_read_b128 v[68:71], v240 offset:704
  ds_read2_b32 v[36:37], v236 offset0:128 offset1:129
  ds_read2_b32 v[38:39], v236 offset0:130 offset1:131
  ds_read_b128 v[72:75], v240 offset:1216
  ds_read2_b32 v[40:41], v237 offset0:0 offset1:1
  ds_read2_b32 v[42:43], v237 offset0:2 offset1:3
  s_waitcnt lgkmcnt(9)
  v_and_b32 v217, 0xffff0000, v20
  v_lshlrev_b32 v216, 16, v20
  ds_read_b128 v[76:79], v240 offset:1728
  ds_read2_b32 v[44:45], v237 offset0:128 offset1:129
  ds_read2_b32 v[46:47], v237 offset0:130 offset1:131
  ds_read_b128 v[80:83], v240 offset:2240
  ds_read2_b32 v[48:49], v238 offset0:0 offset1:1
  ds_read2_b32 v[50:51], v238 offset0:2 offset1:3
  s_waitcnt lgkmcnt(12)
  ds_read_b128 v[84:87], v240 offset:2752
  ds_read2_b32 v[52:53], v238 offset0:128 offset1:129
  ds_read2_b32 v[54:55], v238 offset0:130 offset1:131
  s_waitcnt lgkmcnt(12)
  ds_read_b128 v[88:91], v240 offset:3264
  ds_read2_b32 v[56:57], v239 offset0:0 offset1:1
  ds_read2_b32 v[58:59], v239 offset0:2 offset1:3
  s_waitcnt lgkmcnt(12)
  ds_read_b128 v[92:95], v240 offset:3776
  ds_read2_b32 v[60:61], v239 offset0:128 offset1:129
  ds_read2_b32 v[62:63], v239 offset0:130 offset1:131
  s_waitcnt lgkmcnt(0)
  v_mfma_f32_16x16x32_bf16 v[160:163], v[32:35], v[64:67], 0
  ds_read_b128 v[128:131], v240 offset:128
  v_mfma_f32_16x16x32_bf16 v[164:167], v[32:35], v[68:71], 0
  ds_read2_b32 v[96:97], v236 offset0:16 offset1:17
  v_mfma_f32_16x16x32_bf16 v[168:171], v[32:35], v[72:75], 0
  v_lshlrev_b32_e64 v195, 16, v208
  v_mfma_f32_16x16x32_bf16 v[172:175], v[32:35], v[76:79], 0
  ds_read2_b32 v[98:99], v236 offset0:18 offset1:19
  v_mfma_f32_16x16x32_bf16 v[176:179], v[32:35], v[80:83], 0
  ds_read_b128 v[132:135], v240 offset:640
  v_mfma_f32_16x16x32_bf16 v[180:183], v[32:35], v[84:87], 0
  v_and_b32 v194, 0xffff0000, v208
  v_mfma_f32_16x16x32_bf16 v[184:187], v[32:35], v[88:91], 0
  ds_read2_b32 v[100:101], v236 offset0:144 offset1:145
  v_mfma_f32_16x16x32_bf16 v[188:191], v[32:35], v[92:95], 0
  ds_read2_b32 v[102:103], v236 offset0:146 offset1:147
  v_mfma_f32_16x16x32_bf16 v[164:167], v[36:39], v[64:67], v[164:167]
  v_lshlrev_b32_e64 v193, 16, v209
  v_mfma_f32_16x16x32_bf16 v[168:171], v[36:39], v[68:71], v[168:171]
  ds_read_b128 v[136:139], v240 offset:1152
  v_mfma_f32_16x16x32_bf16 v[172:175], v[36:39], v[72:75], v[172:175]
  ds_read2_b32 v[104:105], v237 offset0:16 offset1:17
  v_mfma_f32_16x16x32_bf16 v[176:179], v[36:39], v[76:79], v[176:179]
  v_and_b32 v192, 0xffff0000, v209
  v_mfma_f32_16x16x32_bf16 v[180:183], v[36:39], v[80:83], v[180:183]
  ds_read2_b32 v[106:107], v237 offset0:18 offset1:19
  v_mfma_f32_16x16x32_bf16 v[184:187], v[36:39], v[84:87], v[184:187]
  ds_read_b128 v[140:143], v240 offset:1664
  v_mfma_f32_16x16x32_bf16 v[188:191], v[36:39], v[88:91], v[188:191]
  v_mul_f32_e64 v192, v216, v192
  v_mfma_f32_16x16x32_bf16 v[168:171], v[40:43], v[64:67], v[168:171]
  ds_read2_b32 v[108:109], v237 offset0:144 offset1:145
  v_mfma_f32_16x16x32_bf16 v[172:175], v[40:43], v[68:71], v[172:175]
  ds_read2_b32 v[110:111], v237 offset0:146 offset1:147
  v_mfma_f32_16x16x32_bf16 v[176:179], v[40:43], v[72:75], v[176:179]
  v_mul_f32_e64 v193, v216, v193
  v_mfma_f32_16x16x32_bf16 v[180:183], v[40:43], v[76:79], v[180:183]
  ds_read_b128 v[144:147], v240 offset:2176
  v_mfma_f32_16x16x32_bf16 v[184:187], v[40:43], v[80:83], v[184:187]
  ds_read2_b32 v[112:113], v238 offset0:16 offset1:17
  v_mfma_f32_16x16x32_bf16 v[188:191], v[40:43], v[84:87], v[188:191]
  v_mul_f32_e64 v194, v216, v194
  v_mfma_f32_16x16x32_bf16 v[172:175], v[44:47], v[64:67], v[172:175]
  ds_read2_b32 v[114:115], v238 offset0:18 offset1:19
  v_mfma_f32_16x16x32_bf16 v[176:179], v[44:47], v[68:71], v[176:179]
  ds_read_b128 v[148:151], v240 offset:2688
  v_mfma_f32_16x16x32_bf16 v[180:183], v[44:47], v[72:75], v[180:183]
  v_mul_f32_e64 v195, v216, v195
  v_mfma_f32_16x16x32_bf16 v[184:187], v[44:47], v[76:79], v[184:187]
  ds_read2_b32 v[116:117], v238 offset0:144 offset1:145
  v_mfma_f32_16x16x32_bf16 v[188:191], v[44:47], v[80:83], v[188:191]
  ds_read2_b32 v[118:119], v238 offset0:146 offset1:147
  v_mfma_f32_16x16x32_bf16 v[176:179], v[48:51], v[64:67], v[176:179]
  v_cvt_pk_bf16_f32 v208, v192, v193
  v_mfma_f32_16x16x32_bf16 v[180:183], v[48:51], v[68:71], v[180:183]
  ds_read_b128 v[152:155], v240 offset:3200
  v_mfma_f32_16x16x32_bf16 v[184:187], v[48:51], v[72:75], v[184:187]
  ds_read2_b32 v[120:121], v239 offset0:16 offset1:17
  v_mfma_f32_16x16x32_bf16 v[188:191], v[48:51], v[76:79], v[188:191]
  v_cvt_pk_bf16_f32 v209, v194, v195
  v_mfma_f32_16x16x32_bf16 v[180:183], v[52:55], v[64:67], v[180:183]
  ds_read2_b32 v[122:123], v239 offset0:18 offset1:19
  v_mfma_f32_16x16x32_bf16 v[184:187], v[52:55], v[68:71], v[184:187]
  ds_read_b128 v[156:159], v240 offset:3712
  v_mfma_f32_16x16x32_bf16 v[188:191], v[52:55], v[72:75], v[188:191]
  v_lshlrev_b32_e64 v192, 16, v208
  v_mfma_f32_16x16x32_bf16 v[184:187], v[56:59], v[64:67], v[184:187]
  ds_read2_b32 v[124:125], v239 offset0:144 offset1:145
  v_mfma_f32_16x16x32_bf16 v[188:191], v[56:59], v[68:71], v[188:191]
  ds_read2_b32 v[126:127], v239 offset0:146 offset1:147
  v_mfma_f32_16x16x32_bf16 v[188:191], v[60:63], v[64:67], v[188:191]
  v_and_b32 v193, 0xffff0000, v208
  s_waitcnt lgkmcnt(0)
  v_mfma_f32_16x16x32_bf16 v[160:163], v[96:99], v[128:131], v[160:163]
  ds_read_b128 v[64:67], v240 offset:64
  v_mfma_f32_16x16x32_bf16 v[164:167], v[96:99], v[132:135], v[164:167]
  ds_read2_b32 v[32:33], v236 offset0:32 offset1:33
  v_mfma_f32_16x16x32_bf16 v[168:171], v[96:99], v[136:139], v[168:171]
  v_lshlrev_b32 v194, 16, v209
  v_mfma_f32_16x16x32_bf16 v[172:175], v[96:99], v[140:143], v[172:175]
  ds_read2_b32 v[34:35], v236 offset0:34 offset1:35
  v_mfma_f32_16x16x32_bf16 v[176:179], v[96:99], v[144:147], v[176:179]
  ds_read_b128 v[68:71], v240 offset:576
  v_mfma_f32_16x16x32_bf16 v[180:183], v[96:99], v[148:151], v[180:183]
  v_and_b32 v195, 0xffff0000, v209
  v_mfma_f32_16x16x32_bf16 v[184:187], v[96:99], v[152:155], v[184:187]
  ds_read2_b32 v[36:37], v236 offset0:160 offset1:161
  v_mfma_f32_16x16x32_bf16 v[188:191], v[96:99], v[156:159], v[188:191]
  ds_read2_b32 v[38:39], v236 offset0:162 offset1:163
  v_mfma_f32_16x16x32_bf16 v[164:167], v[100:103], v[128:131], v[164:167]
  v_lshlrev_b32_e64 v199, 16, v210
  v_mfma_f32_16x16x32_bf16 v[168:171], v[100:103], v[132:135], v[168:171]
  ds_read_b128 v[72:75], v240 offset:1088
  v_mfma_f32_16x16x32_bf16 v[172:175], v[100:103], v[136:139], v[172:175]
  ds_read2_b32 v[40:41], v237 offset0:32 offset1:33
  v_mfma_f32_16x16x32_bf16 v[176:179], v[100:103], v[140:143], v[176:179]
  v_and_b32 v198, 0xffff0000, v210
  v_mfma_f32_16x16x32_bf16 v[180:183], v[100:103], v[144:147], v[180:183]
  ds_read2_b32 v[42:43], v237 offset0:34 offset1:35
  v_mfma_f32_16x16x32_bf16 v[184:187], v[100:103], v[148:151], v[184:187]
  ds_read_b128 v[76:79], v240 offset:1600
  v_mfma_f32_16x16x32_bf16 v[188:191], v[100:103], v[152:155], v[188:191]
  v_lshlrev_b32_e64 v197, 16, v211
  v_mfma_f32_16x16x32_bf16 v[168:171], v[104:107], v[128:131], v[168:171]
  ds_read2_b32 v[44:45], v237 offset0:160 offset1:161
  v_mfma_f32_16x16x32_bf16 v[172:175], v[104:107], v[132:135], v[172:175]
  ds_read2_b32 v[46:47], v237 offset0:162 offset1:163
  v_mfma_f32_16x16x32_bf16 v[176:179], v[104:107], v[136:139], v[176:179]
  v_and_b32 v196, 0xffff0000, v211
  v_mfma_f32_16x16x32_bf16 v[180:183], v[104:107], v[140:143], v[180:183]
  ds_read_b128 v[80:83], v240 offset:2112
  v_mfma_f32_16x16x32_bf16 v[184:187], v[104:107], v[144:147], v[184:187]
  ds_read2_b32 v[48:49], v238 offset0:32 offset1:33
  v_mfma_f32_16x16x32_bf16 v[188:191], v[104:107], v[148:151], v[188:191]
  v_mul_f32_e64 v196, v216, v196
  v_mfma_f32_16x16x32_bf16 v[172:175], v[108:111], v[128:131], v[172:175]
  ds_read2_b32 v[50:51], v238 offset0:34 offset1:35
  v_mfma_f32_16x16x32_bf16 v[176:179], v[108:111], v[132:135], v[176:179]
  ds_read_b128 v[84:87], v240 offset:2624
  v_mfma_f32_16x16x32_bf16 v[180:183], v[108:111], v[136:139], v[180:183]
  v_mul_f32_e64 v197, v216, v197
  v_mfma_f32_16x16x32_bf16 v[184:187], v[108:111], v[140:143], v[184:187]
  ds_read2_b32 v[52:53], v238 offset0:160 offset1:161
  v_mfma_f32_16x16x32_bf16 v[188:191], v[108:111], v[144:147], v[188:191]
  ds_read2_b32 v[54:55], v238 offset0:162 offset1:163
  v_mfma_f32_16x16x32_bf16 v[176:179], v[112:115], v[128:131], v[176:179]
  v_mul_f32_e64 v198, v216, v198
  v_mfma_f32_16x16x32_bf16 v[180:183], v[112:115], v[132:135], v[180:183]
  ds_read_b128 v[88:91], v240 offset:3136
  v_mfma_f32_16x16x32_bf16 v[184:187], v[112:115], v[136:139], v[184:187]
  ds_read2_b32 v[56:57], v239 offset0:32 offset1:33
  v_mfma_f32_16x16x32_bf16 v[188:191], v[112:115], v[140:143], v[188:191]
  v_mul_f32_e64 v199, v216, v199
  v_mfma_f32_16x16x32_bf16 v[180:183], v[116:119], v[128:131], v[180:183]
  ds_read2_b32 v[58:59], v239 offset0:34 offset1:35
  v_mfma_f32_16x16x32_bf16 v[184:187], v[116:119], v[132:135], v[184:187]
  ds_read_b128 v[92:95], v240 offset:3648
  v_mfma_f32_16x16x32_bf16 v[188:191], v[116:119], v[136:139], v[188:191]
  v_cvt_pk_bf16_f32 v210, v196, v197
  v_mfma_f32_16x16x32_bf16 v[184:187], v[120:123], v[128:131], v[184:187]
  ds_read2_b32 v[60:61], v239 offset0:160 offset1:161
  v_mfma_f32_16x16x32_bf16 v[188:191], v[120:123], v[132:135], v[188:191]
  ds_read2_b32 v[62:63], v239 offset0:162 offset1:163
  v_mfma_f32_16x16x32_bf16 v[188:191], v[124:127], v[128:131], v[188:191]
  v_cvt_pk_bf16_f32 v211, v198, v199
  s_waitcnt lgkmcnt(0)
  v_mfma_f32_16x16x32_bf16 v[160:163], v[32:35], v[64:67], v[160:163]
  ds_read_b128 v[128:131], v240 offset:0
  v_mfma_f32_16x16x32_bf16 v[164:167], v[32:35], v[68:71], v[164:167]
  ds_read2_b32 v[96:97], v236 offset0:48 offset1:49
  v_mfma_f32_16x16x32_bf16 v[168:171], v[32:35], v[72:75], v[168:171]
  v_lshlrev_b32 v196, 16, v210
  v_mfma_f32_16x16x32_bf16 v[172:175], v[32:35], v[76:79], v[172:175]
  ds_read2_b32 v[98:99], v236 offset0:50 offset1:51
  v_mfma_f32_16x16x32_bf16 v[176:179], v[32:35], v[80:83], v[176:179]
  ds_read_b128 v[132:135], v240 offset:512
  v_mfma_f32_16x16x32_bf16 v[180:183], v[32:35], v[84:87], v[180:183]
  v_and_b32 v197, 0xffff0000, v210
  v_mfma_f32_16x16x32_bf16 v[184:187], v[32:35], v[88:91], v[184:187]
  ds_read2_b32 v[100:101], v236 offset0:176 offset1:177
  v_mfma_f32_16x16x32_bf16 v[188:191], v[32:35], v[92:95], v[188:191]
  ds_read2_b32 v[102:103], v236 offset0:178 offset1:179
  v_mfma_f32_16x16x32_bf16 v[164:167], v[36:39], v[64:67], v[164:167]
  v_lshlrev_b32_e64 v198, 16, v211
  v_mfma_f32_16x16x32_bf16 v[168:171], v[36:39], v[68:71], v[168:171]
  ds_read_b128 v[136:139], v240 offset:1024
  v_mfma_f32_16x16x32_bf16 v[172:175], v[36:39], v[72:75], v[172:175]
  ds_read2_b32 v[104:105], v237 offset0:48 offset1:49
  v_mfma_f32_16x16x32_bf16 v[176:179], v[36:39], v[76:79], v[176:179]
  v_and_b32 v199, 0xffff0000, v211
  v_mfma_f32_16x16x32_bf16 v[180:183], v[36:39], v[80:83], v[180:183]
  ds_read2_b32 v[106:107], v237 offset0:50 offset1:51
  v_mfma_f32_16x16x32_bf16 v[184:187], v[36:39], v[84:87], v[184:187]
  ds_read_b128 v[140:143], v240 offset:1536
  v_mfma_f32_16x16x32_bf16 v[188:191], v[36:39], v[88:91], v[188:191]
  v_lshlrev_b32_e64 v203, 16, v212
  v_mfma_f32_16x16x32_bf16 v[168:171], v[40:43], v[64:67], v[168:171]
  ds_read2_b32 v[108:109], v237 offset0:176 offset1:177
  v_mfma_f32_16x16x32_bf16 v[172:175], v[40:43], v[68:71], v[172:175]
  ds_read2_b32 v[110:111], v237 offset0:178 offset1:179
  v_mfma_f32_16x16x32_bf16 v[176:179], v[40:43], v[72:75], v[176:179]
  v_and_b32 v202, 0xffff0000, v212
  v_mfma_f32_16x16x32_bf16 v[180:183], v[40:43], v[76:79], v[180:183]
  ds_read_b128 v[144:147], v240 offset:2048
  v_mfma_f32_16x16x32_bf16 v[184:187], v[40:43], v[80:83], v[184:187]
  ds_read2_b32 v[112:113], v238 offset0:48 offset1:49
  v_mfma_f32_16x16x32_bf16 v[188:191], v[40:43], v[84:87], v[188:191]
  v_lshlrev_b32_e64 v201, 16, v213
  v_mfma_f32_16x16x32_bf16 v[172:175], v[44:47], v[64:67], v[172:175]
  ds_read2_b32 v[114:115], v238 offset0:50 offset1:51
  v_mfma_f32_16x16x32_bf16 v[176:179], v[44:47], v[68:71], v[176:179]
  ds_read_b128 v[148:151], v240 offset:2560
  v_mfma_f32_16x16x32_bf16 v[180:183], v[44:47], v[72:75], v[180:183]
  v_and_b32 v200, 0xffff0000, v213
  v_mfma_f32_16x16x32_bf16 v[184:187], v[44:47], v[76:79], v[184:187]
  ds_read2_b32 v[116:117], v238 offset0:176 offset1:177
  v_mfma_f32_16x16x32_bf16 v[188:191], v[44:47], v[80:83], v[188:191]
  ds_read2_b32 v[118:119], v238 offset0:178 offset1:179
  v_mfma_f32_16x16x32_bf16 v[176:179], v[48:51], v[64:67], v[176:179]
  v_mul_f32_e64 v200, v217, v200
  v_mfma_f32_16x16x32_bf16 v[180:183], v[48:51], v[68:71], v[180:183]
  ds_read_b128 v[152:155], v240 offset:3072
  v_mfma_f32_16x16x32_bf16 v[184:187], v[48:51], v[72:75], v[184:187]
  ds_read2_b32 v[120:121], v239 offset0:48 offset1:49
  v_mfma_f32_16x16x32_bf16 v[188:191], v[48:51], v[76:79], v[188:191]
  v_mul_f32_e64 v201, v217, v201
  v_mfma_f32_16x16x32_bf16 v[180:183], v[52:55], v[64:67], v[180:183]
  ds_read2_b32 v[122:123], v239 offset0:50 offset1:51
  v_mfma_f32_16x16x32_bf16 v[184:187], v[52:55], v[68:71], v[184:187]
  ds_read_b128 v[156:159], v240 offset:3584
  v_mfma_f32_16x16x32_bf16 v[188:191], v[52:55], v[72:75], v[188:191]
  v_mul_f32_e64 v202, v217, v202
  v_mfma_f32_16x16x32_bf16 v[184:187], v[56:59], v[64:67], v[184:187]
  ds_read2_b32 v[124:125], v239 offset0:176 offset1:177
  v_mfma_f32_16x16x32_bf16 v[188:191], v[56:59], v[68:71], v[188:191]
  ds_read2_b32 v[126:127], v239 offset0:178 offset1:179
  v_mfma_f32_16x16x32_bf16 v[188:191], v[60:63], v[64:67], v[188:191]
  v_mul_f32 v203, v217, v203
  s_waitcnt lgkmcnt(0)
  v_mfma_f32_16x16x32_bf16 v[160:163], v[96:99], v[128:131], v[160:163]
  v_cvt_pk_bf16_f32 v212, v200, v201
  v_mfma_f32_16x16x32_bf16 v[164:167], v[96:99], v[132:135], v[164:167]
  v_cvt_pk_bf16_f32 v213, v202, v203
  v_mfma_f32_16x16x32_bf16 v[168:171], v[96:99], v[136:139], v[168:171]
  v_lshlrev_b32_e64 v200, 16, v212
  v_mfma_f32_16x16x32_bf16 v[172:175], v[96:99], v[140:143], v[172:175]
  v_and_b32 v201, 0xffff0000, v212
  v_mfma_f32_16x16x32_bf16 v[176:179], v[96:99], v[144:147], v[176:179]
  v_lshlrev_b32_e64 v202, 16, v213
  v_mfma_f32_16x16x32_bf16 v[180:183], v[96:99], v[148:151], v[180:183]
  v_and_b32 v203, 0xffff0000, v213
  v_mfma_f32_16x16x32_bf16 v[184:187], v[96:99], v[152:155], v[184:187]
  v_lshlrev_b32_e64 v207, 16, v214
  v_mfma_f32_16x16x32_bf16 v[188:191], v[96:99], v[156:159], v[188:191]
  v_and_b32 v206, 0xffff0000, v214
  v_mfma_f32_16x16x32_bf16 v[164:167], v[100:103], v[128:131], v[164:167]
  v_lshlrev_b32_e64 v205, 16, v215
  v_mfma_f32_16x16x32_bf16 v[168:171], v[100:103], v[132:135], v[168:171]
  v_and_b32 v204, 0xffff0000, v215
  v_mfma_f32_16x16x32_bf16 v[172:175], v[100:103], v[136:139], v[172:175]
  v_mul_f32_e64 v204, v217, v204
  v_mfma_f32_16x16x32_bf16 v[176:179], v[100:103], v[140:143], v[176:179]
  v_mul_f32_e64 v205, v217, v205
  v_mfma_f32_16x16x32_bf16 v[180:183], v[100:103], v[144:147], v[180:183]
  v_mul_f32_e64 v206, v217, v206
  v_mfma_f32_16x16x32_bf16 v[184:187], v[100:103], v[148:151], v[184:187]
  v_mul_f32_e64 v207, v217, v207
  v_mfma_f32_16x16x32_bf16 v[188:191], v[100:103], v[152:155], v[188:191]
  v_cvt_pk_bf16_f32 v214, v204, v205
  v_mfma_f32_16x16x32_bf16 v[168:171], v[104:107], v[128:131], v[168:171]
  v_cvt_pk_bf16_f32 v215, v206, v207
  v_mfma_f32_16x16x32_bf16 v[172:175], v[104:107], v[132:135], v[172:175]
  v_lshlrev_b32_e64 v204, 16, v214
  v_mfma_f32_16x16x32_bf16 v[176:179], v[104:107], v[136:139], v[176:179]
  v_and_b32 v205, 0xffff0000, v214
  v_mfma_f32_16x16x32_bf16 v[180:183], v[104:107], v[140:143], v[180:183]
  v_lshlrev_b32_e64 v206, 16, v215
  v_mfma_f32_16x16x32_bf16 v[184:187], v[104:107], v[144:147], v[184:187]
  v_and_b32 v207, 0xffff0000, v215
  v_mfma_f32_16x16x32_bf16 v[188:191], v[104:107], v[148:151], v[188:191]
  v_mfma_f32_16x16x32_bf16 v[172:175], v[108:111], v[128:131], v[172:175]
  v_mfma_f32_16x16x32_bf16 v[176:179], v[108:111], v[132:135], v[176:179]
  v_mfma_f32_16x16x32_bf16 v[180:183], v[108:111], v[136:139], v[180:183]
  v_mfma_f32_16x16x32_bf16 v[184:187], v[108:111], v[140:143], v[184:187]
  v_mfma_f32_16x16x32_bf16 v[188:191], v[108:111], v[144:147], v[188:191]
  v_mfma_f32_16x16x32_bf16 v[176:179], v[112:115], v[128:131], v[176:179]
  v_mfma_f32_16x16x32_bf16 v[180:183], v[112:115], v[132:135], v[180:183]
  v_mfma_f32_16x16x32_bf16 v[184:187], v[112:115], v[136:139], v[184:187]
  v_mfma_f32_16x16x32_bf16 v[188:191], v[112:115], v[140:143], v[188:191]
  v_mfma_f32_16x16x32_bf16 v[180:183], v[116:119], v[128:131], v[180:183]
  v_mfma_f32_16x16x32_bf16 v[184:187], v[116:119], v[132:135], v[184:187]
  v_mfma_f32_16x16x32_bf16 v[188:191], v[116:119], v[136:139], v[188:191]
  v_mfma_f32_16x16x32_bf16 v[184:187], v[120:123], v[128:131], v[184:187]
  v_mfma_f32_16x16x32_bf16 v[188:191], v[120:123], v[132:135], v[188:191]
  v_mfma_f32_16x16x32_bf16 v[188:191], v[124:127], v[128:131], v[188:191]
  s_setprio 3
  s_cmp_lg_u32 s42, 0
  s_cbranch_scc1 L_cx1
  ds_write_b128 v16, v[168:171] offset:32128
  ds_write_b128 v16, v[172:175] offset:33152
  ds_write_b128 v16, v[176:179] offset:40320
  ds_write_b128 v16, v[180:183] offset:41344
  ds_write_b128 v16, v[184:187] offset:48512
  ds_write_b128 v16, v[188:191] offset:49536
  s_mov_b64 exec, 1
  ds_add_u32 v1, v2 offset:16
  s_mov_b64 exec, -1
  v_add_f32 v160, v160, v192
  v_add_f32 v161, v161, v193
  v_add_f32 v162, v162, v194
  v_add_f32 v163, v163, v195
  v_add_f32 v164, v164, v196
  v_add_f32 v165, v165, v197
  v_add_f32 v166, v166, v198
  v_add_f32 v167, v167, v199
  ds_read_b32 v3, v1 offset:16
  s_waitcnt lgkmcnt(0)
  v_readfirstlane_b32 s15, v3
  s_nop 0
  s_cmp_ge_u32 s15, 4
  s_cbranch_scc1 L_lwd_28
L_lw_27:
  s_sleep 1
  ds_read_b32 v3, v1 offset:16
  s_sub_u32 s76, s76, 1
  s_waitcnt lgkmcnt(0)
  v_readfirstlane_b32 s15, v3
  s_cmp_lt_i32 s76, 0
  s_cselect_b32 s15, 4, s15
  s_cmp_ge_u32 s15, 4
  s_cbranch_scc0 L_lw_27
L_lwd_28:
  ds_read_b128 v[40:43], v4 offset:0
  ds_read_b128 v[44:47], v4 offset:1024
  ds_read_b128 v[48:51], v4 offset:2048
  ds_read_b128 v[52:55], v4 offset:3072
  ds_read_b128 v[56:59], v4 offset:4096
  ds_read_b128 v[60:63], v4 offset:5120
  s_waitcnt lgkmcnt(4)
  v_add_f32 v32, v160, v40
  v_add_f32 v33, v161, v41
  v_add_f32 v34, v162, v42
  v_add_f32 v35, v163, v43
  v_add_f32 v36, v164, v44
  v_add_f32 v37, v165, v45
  v_add_f32 v38, v166, v46
  v_add_f32 v39, v167, v47
  s_waitcnt lgkmcnt(2)
  v_add_f32 v48, v48, v200
  v_add_f32 v49, v49, v201
  v_add_f32 v50, v50, v202
  v_add_f32 v51, v51, v203
  v_add_f32 v52, v52, v204
  v_add_f32 v53, v53, v205
  v_add_f32 v54, v54, v206
  v_add_f32 v55, v55, v207
  s_waitcnt lgkmcnt(0)
  v_add_f32 v40, v48, v56
  v_add_f32 v41, v49, v57
  v_add_f32 v42, v50, v58
  v_add_f32 v43, v51, v59
  v_add_f32 v44, v52, v60
  v_add_f32 v45, v53, v61
  v_add_f32 v46, v54, v62
  v_add_f32_e64 v47, v55, v63
  v_cvt_pk_bf16_f32 v48, v32, v40
  v_cvt_pk_bf16_f32 v49, v33, v41
  v_cvt_pk_bf16_f32 v50, v34, v42
  v_cvt_pk_bf16_f32 v51, v35, v43
  v_cvt_pk_bf16_f32 v52, v36, v44
  v_cvt_pk_bf16_f32 v53, v37, v45
  v_cvt_pk_bf16_f32 v54, v38, v46
  v_cvt_pk_bf16_f32 v55, v39, v47
  s_branch L_cxd
L_cx1:
  s_cmp_lg_u32 s42, 1
  s_cbranch_scc1 L_cx2
  ds_write_b128 v16, v[160:163] offset:25984
  ds_write_b128 v16, v[164:167] offset:27008
  ds_write_b128 v16, v[184:187] offset:46464
  ds_write_b128 v16, v[188:191] offset:47488
  ds_write_b128 v16, v[176:179] offset:42368
  ds_write_b128 v16, v[180:183] offset:43392
  s_mov_b64 exec, 1
  ds_add_u32 v1, v2 offset:16
  s_mov_b64 exec, -1
  v_add_f32 v168, v168, v192
  v_add_f32 v169, v169, v193
  v_add_f32 v170, v170, v194
  v_add_f32 v171, v171, v195
  v_add_f32 v172, v172, v196
  v_add_f32 v173, v173, v197
  v_add_f32 v174, v174, v198
  v_add_f32 v175, v175, v199
  ds_read_b32 v3, v1 offset:16
  s_waitcnt lgkmcnt(0)
  v_readfirstlane_b32 s15, v3
  s_nop 0
  s_cmp_ge_u32 s15, 4
  s_cbranch_scc1 L_lwd_30
L_lw_29:
  s_sleep 1
  ds_read_b32 v3, v1 offset:16
  s_sub_u32 s76, s76, 1
  s_waitcnt lgkmcnt(0)
  v_readfirstlane_b32 s15, v3
  s_cmp_lt_i32 s76, 0
  s_cselect_b32 s15, 4, s15
  s_cmp_ge_u32 s15, 4
  s_cbranch_scc0 L_lw_29
L_lwd_30:
  ds_read_b128 v[40:43], v4 offset:0
  ds_read_b128 v[44:47], v4 offset:1024
  ds_read_b128 v[48:51], v4 offset:2048
  ds_read_b128 v[52:55], v4 offset:3072
  ds_read_b128 v[56:59], v4 offset:4096
  ds_read_b128 v[60:63], v4 offset:5120
  s_waitcnt lgkmcnt(4)
  v_add_f32 v32, v168, v40
  v_add_f32 v33, v169, v41
  v_add_f32 v34, v170, v42
  v_add_f32 v35, v171, v43
  v_add_f32 v36, v172, v44
  v_add_f32 v37, v173, v45
  v_add_f32 v38, v174, v46
  v_add_f32 v39, v175, v47
  s_waitcnt lgkmcnt(2)
  v_add_f32 v48, v48, v200
  v_add_f32 v49, v49, v201
  v_add_f32 v50, v50, v202
  v_add_f32 v51, v51, v203
  v_add_f32 v52, v52, v204
  v_add_f32 v53, v53, v205
  v_add_f32 v54, v54, v206
  v_add_f32 v55, v55, v207
  s_waitcnt lgkmcnt(0)
  v_add_f32 v40, v48, v56
  v_add_f32 v41, v49, v57
  v_add_f32 v42, v50, v58
  v_add_f32 v43, v51, v59
  v_add_f32 v44, v52, v60
  v_add_f32 v45, v53, v61
  v_add_f32 v46, v54, v62
  v_add_f32_e64 v47, v55, v63
  v_cvt_pk_bf16_f32 v48, v32, v40
  v_cvt_pk_bf16_f32 v49, v33, v41
  v_cvt_pk_bf16_f32 v50, v34, v42
  v_cvt_pk_bf16_f32 v51, v35, v43
  v_cvt_pk_bf16_f32 v52, v36, v44
  v_cvt_pk_bf16_f32 v53, v37, v45
  v_cvt_pk_bf16_f32 v54, v38, v46
  v_cvt_pk_bf16_f32 v55, v39, v47
  s_branch L_cxd
L_cx2:
  s_cmp_lg_u32 s42, 2
  s_cbranch_scc1 L_cx3
  ds_write_b128 v16, v[184:187] offset:44416
  ds_write_b128 v16, v[188:191] offset:45440
  ds_write_b128 v16, v[160:163] offset:28032
  ds_write_b128 v16, v[164:167] offset:29056
  ds_write_b128 v16, v[168:171] offset:36224
  ds_write_b128 v16, v[172:175] offset:37248
  s_mov_b64 exec, 1
  ds_add_u32 v1, v2 offset:16
  s_mov_b64 exec, -1
  v_add_f32 v176, v176, v200
  v_add_f32 v177, v177, v201
  v_add_f32 v178, v178, v202
  v_add_f32 v179, v179, v203
  v_add_f32 v180, v180, v204
  v_add_f32 v181, v181, v205
  v_add_f32 v182, v182, v206
  v_add_f32 v183, v183, v207
  ds_read_b32 v3, v1 offset:16
  s_waitcnt lgkmcnt(0)
  v_readfirstlane_b32 s15, v3
  s_nop 0
  s_cmp_ge_u32 s15, 4
  s_cbranch_scc1 L_lwd_32
L_lw_31:
  s_sleep 1
  ds_read_b32 v3, v1 offset:16
  s_sub_u32 s76, s76, 1
  s_waitcnt lgkmcnt(0)
  v_readfirstlane_b32 s15, v3
  s_cmp_lt_i32 s76, 0
  s_cselect_b32 s15, 4, s15
  s_cmp_ge_u32 s15, 4
  s_cbranch_scc0 L_lw_31
L_lwd_32:
  ds_read_b128 v[40:43], v4 offset:0
  ds_read_b128 v[44:47], v4 offset:1024
  ds_read_b128 v[48:51], v4 offset:2048
  ds_read_b128 v[52:55], v4 offset:3072
  ds_read_b128 v[56:59], v4 offset:4096
  ds_read_b128 v[60:63], v4 offset:5120
  s_waitcnt lgkmcnt(4)
  v_add_f32 v32, v176, v40
  v_add_f32 v33, v177, v41
  v_add_f32 v34, v178, v42
  v_add_f32 v35, v179, v43
  v_add_f32 v36, v180, v44
  v_add_f32 v37, v181, v45
  v_add_f32 v38, v182, v46
  v_add_f32 v39, v183, v47
  s_waitcnt lgkmcnt(2)
  v_add_f32 v48, v48, v192
  v_add_f32 v49, v49, v193
  v_add_f32 v50, v50, v194
  v_add_f32 v51, v51, v195
  v_add_f32 v52, v52, v196
  v_add_f32 v53, v53, v197
  v_add_f32 v54, v54, v198
  v_add_f32 v55, v55, v199
  s_waitcnt lgkmcnt(0)
  v_add_f32 v40, v48, v56
  v_add_f32 v41, v49, v57
  v_add_f32 v42, v50, v58
  v_add_f32 v43, v51, v59
  v_add_f32 v44, v52, v60
  v_add_f32 v45, v53, v61
  v_add_f32 v46, v54, v62
  v_add_f32_e64 v47, v55, v63
  v_cvt_pk_bf16_f32 v48, v40, v32
  v_cvt_pk_bf16_f32 v49, v41, v33
  v_cvt_pk_bf16_f32 v50, v42, v34
  v_cvt_pk_bf16_f32 v51, v43, v35
  v_cvt_pk_bf16_f32 v52, v44, v36
  v_cvt_pk_bf16_f32 v53, v45, v37
  v_cvt_pk_bf16_f32 v54, v46, v38
  v_cvt_pk_bf16_f32 v55, v47, v39
  s_branch L_cxd
L_cx3:
  ds_write_b128 v16, v[176:179] offset:38272
  ds_write_b128 v16, v[180:183] offset:39296
  ds_write_b128 v16, v[168:171] offset:34176
  ds_write_b128 v16, v[172:175] offset:35200
  ds_write_b128 v16, v[160:163] offset:30080
  ds_write_b128 v16, v[164:167] offset:31104
  s_mov_b64 exec, 1
  ds_add_u32 v1, v2 offset:16
  s_mov_b64 exec, -1
  v_add_f32 v184, v184, v200
  v_add_f32 v185, v185, v201
  v_add_f32 v186, v186, v202
  v_add_f32 v187, v187, v203
  v_add_f32 v188, v188, v204
  v_add_f32 v189, v189, v205
  v_add_f32 v190, v190, v206
  v_add_f32 v191, v191, v207
  ds_read_b32 v3, v1 offset:16
  s_waitcnt lgkmcnt(0)
  v_readfirstlane_b32 s15, v3
  s_nop 0
  s_cmp_ge_u32 s15, 4
  s_cbranch_scc1 L_lwd_34
L_lw_33:
  s_sleep 1
  ds_read_b32 v3, v1 offset:16
  s_sub_u32 s76, s76, 1
  s_waitcnt lgkmcnt(0)
  v_readfirstlane_b32 s15, v3
  s_cmp_lt_i32 s76, 0
  s_cselect_b32 s15, 4, s15
  s_cmp_ge_u32 s15, 4
  s_cbranch_scc0 L_lw_33
L_lwd_34:
  ds_read_b128 v[40:43], v4 offset:0
  ds_read_b128 v[44:47], v4 offset:1024
  ds_read_b128 v[48:51], v4 offset:2048
  ds_read_b128 v[52:55], v4 offset:3072
  ds_read_b128 v[56:59], v4 offset:4096
  ds_read_b128 v[60:63], v4 offset:5120
  s_waitcnt lgkmcnt(4)
  v_add_f32 v32, v184, v40
  v_add_f32 v33, v185, v41
  v_add_f32 v34, v186, v42
  v_add_f32 v35, v187, v43
  v_add_f32 v36, v188, v44
  v_add_f32 v37, v189, v45
  v_add_f32 v38, v190, v46
  v_add_f32 v39, v191, v47
  s_waitcnt lgkmcnt(2)
  v_add_f32 v48, v48, v192
  v_add_f32 v49, v49, v193
  v_add_f32 v50, v50, v194
  v_add_f32 v51, v51, v195
  v_add_f32 v52, v52, v196
  v_add_f32 v53, v53, v197
  v_add_f32 v54, v54, v198
  v_add_f32 v55, v55, v199
  s_waitcnt lgkmcnt(0)
  v_add_f32 v40, v48, v56
  v_add_f32 v41, v49, v57
  v_add_f32 v42, v50, v58
  v_add_f32 v43, v51, v59
  v_add_f32 v44, v52, v60
  v_add_f32 v45, v53, v61
  v_add_f32 v46, v54, v62
  v_add_f32_e64 v47, v55, v63
  v_cvt_pk_bf16_f32 v48, v40, v32
  v_cvt_pk_bf16_f32 v49, v41, v33
  v_cvt_pk_bf16_f32 v50, v42, v34
  v_cvt_pk_bf16_f32 v51, v43, v35
  v_cvt_pk_bf16_f32 v52, v44, v36
  v_cvt_pk_bf16_f32 v53, v45, v37
  v_cvt_pk_bf16_f32 v54, v46, v38
  v_cvt_pk_bf16_f32 v55, v47, v39
L_cxd:
  buffer_store_dwordx4 v[48:51], v241, s[44:47], s52 offen offset:0 sc1
  buffer_store_dwordx4 v[52:55], v241, s[44:47], s52 offen offset:1024 sc1
  s_mov_b32 m0, s87
  s_nop 0
  buffer_load_dwordx4 v5, s[48:51], s86 offen lds
  buffer_load_dwordx4 v9, s[48:51], s86 offen offset:1024 lds
  buffer_load_dwordx4 v[12:15], v10, s[44:47], s62 offen sc1
  v_lshrrev_b32 v237, 3, v0
  v_and_b32 v236, 7, v0
  v_lshlrev_b32 v232, 1, v236
  v_xor_b32 v232, v232, v237
  v_lshlrev_b32 v232, 4, v232
  v_lshl_add_u32 v232, v237, 8, v232
  s_lshl_b32 s15, s3, 11
  s_add_u32 s15, s15, 9344
  v_add_u32_e64 v234, s15, v232
  v_xor_b32 v235, 16, v234
  s_lshl_b32 s15, s3, 13
  s_add_u32 s15, s15, 50688
  v_add_u32 v232, s15, v232
  v_xor_b32 v233, 16, v232
  v_lshlrev_b32 v236, 4, v236
  v_lshl_add_u32 v238, v237, 10, v236
  s_lshl_b32 s15, s3, 5
  s_add_u32 s15, s15, 128
  v_lshl_add_u32 v236, v237, 2, s15
  s_lshl_b32 s43, s10, 16
  s_lshl_b32 s15, s3, 13
  s_add_u32 s43, s43, s15
  s_lshl_b32 s15, s11, 7
  s_add_u32 s43, s43, s15
  s_waitcnt vmcnt(3)
  s_mov_b32 s60, s14
  s_atomic_swap s60, s[40:41], s53
  s_mov_b32 s71, s14
  s_atomic_swap s71, s[40:41], s61
  s_waitcnt vmcnt(1)
  ds_read_b128 v[64:67], v6
  ds_read_b128 v[68:71], v6 offset:16
  s_waitcnt lgkmcnt(0)
  v_and_b32 v73, 0xffff0000, v64
  v_lshlrev_b32_e64 v72, 16, v64
  v_and_b32 v75, 0xffff0000, v65
  v_lshlrev_b32_e64 v74, 16, v65
  v_and_b32 v77, 0xffff0000, v66
  v_lshlrev_b32_e64 v76, 16, v66
  v_and_b32 v79, 0xffff0000, v67
  v_lshlrev_b32_e64 v78, 16, v67
  v_and_b32 v81, 0xffff0000, v68
  v_lshlrev_b32_e64 v80, 16, v68
  v_and_b32 v83, 0xffff0000, v69
  v_lshlrev_b32_e64 v82, 16, v69
  v_and_b32 v85, 0xffff0000, v70
  v_lshlrev_b32_e64 v84, 16, v70
  v_and_b32 v87, 0xffff0000, v71
  v_lshlrev_b32 v86, 16, v71
  s_waitcnt vmcnt(0)
  v_cmp_ne_u32 s[24:25], s14, v12
  v_cmp_ne_u32 vcc, s14, v14
  s_nop 0
  s_or_b64 vcc, vcc, s[24:25]
  s_cbranch_vccz L_pd_36
  s_mov_b64 exec, vcc
L_p_35:
  s_sleep 4
  buffer_load_dwordx4 v[12:15], v10, s[44:47], s62 offen sc1
  s_sub_u32 s76, s76, 1
  s_waitcnt vmcnt(0)
  v_cmp_ne_u32 s[24:25], s14, v12
  v_cmp_ne_u32 vcc, s14, v14
  s_nop 0
  s_or_b64 vcc, vcc, s[24:25]
  s_cmp_gt_i32 s76, 0
  s_cselect_b64 exec, vcc, 0
  s_cbranch_execnz L_p_35
L_pd_36:
  s_mov_b64 exec, -1
  v_and_b32 v3, 1, v0
  v_lshlrev_b32 v3, 4, v3
  v_lshrrev_b32 v3, v3, v15
  v_lshlrev_b32_e64 v3, 16, v3
  v_rcp_f32 v3, v3
  s_nop 0
  ds_write_b32 v11, v3
  s_mov_b32 s92, s14
  s_mov_b32 s93, s14
L_sp_37:
  s_sleep 2
  s_load_dwordx16 s[16:31], s[40:41], s54 glc
L_spe_38:
  s_sub_u32 s76, s76, 1
  s_waitcnt lgkmcnt(0)
  s_xor_b64 s[16:17], s[16:17], s[92:93]
  s_xor_b64 s[18:19], s[18:19], s[92:93]
  s_xor_b64 s[20:21], s[20:21], s[92:93]
  s_xor_b64 s[22:23], s[22:23], s[92:93]
  s_xor_b64 s[24:25], s[24:25], s[92:93]
  s_xor_b64 s[26:27], s[26:27], s[92:93]
  s_xor_b64 s[28:29], s[28:29], s[92:93]
  s_xor_b64 s[30:31], s[30:31], s[92:93]
  s_or_b64 s[16:17], s[16:17], s[18:19]
  s_or_b64 s[16:17], s[16:17], s[20:21]
  s_or_b64 s[16:17], s[16:17], s[22:23]
  s_or_b64 s[16:17], s[16:17], s[24:25]
  s_or_b64 s[16:17], s[16:17], s[26:27]
  s_or_b64 s[16:17], s[16:17], s[28:29]
  s_or_b64 s[16:17], s[16:17], s[30:31]
  s_cmp_gt_i32 s76, 0
  s_cselect_b64 s[16:17], s[16:17], 0
  s_cmp_eq_u64 s[16:17], 0
  s_cbranch_scc0 L_sp_37
  s_mov_b32 s60, s36
  s_mov_b32 s61, s37
  s_mov_b32 s62, 2097152
  s_mov_b32 s63, 0x20000
  buffer_load_dword v32, v7, s[44:47], s55 offen sc1
  s_add_u32 s55, s55, 8192
  buffer_load_dword v33, v7, s[44:47], s55 offen sc1
  s_add_u32 s55, s55, 8192
  buffer_load_dword v34, v7, s[44:47], s55 offen sc1
  s_add_u32 s55, s55, 8192
  buffer_load_dword v35, v7, s[44:47], s55 offen sc1
  s_add_u32 s55, s55, 8192
  buffer_load_dword v36, v7, s[44:47], s55 offen sc1
  s_add_u32 s55, s55, 8192
  buffer_load_dword v37, v7, s[44:47], s55 offen sc1
  s_add_u32 s55, s55, 8192
  buffer_load_dword v38, v7, s[44:47], s55 offen sc1
  s_add_u32 s55, s55, 8192
  buffer_load_dword v39, v7, s[44:47], s55 offen sc1
  s_waitcnt vmcnt(7)
  v_and_b32 v41, 0xffff0000, v32
  v_lshlrev_b32 v40, 16, v32
  v_add_f32_e64 v40, v40, v72
  v_add_f32 v41, v41, v73
  s_waitcnt vmcnt(6)
  v_and_b32 v43, 0xffff0000, v33
  v_lshlrev_b32 v42, 16, v33
  v_add_f32 v42, v42, v74
  v_add_f32 v43, v43, v75
  ds_write_b128 v8, v[40:43]
  s_waitcnt vmcnt(5)
  v_and_b32 v45, 0xffff0000, v34
  v_lshlrev_b32 v44, 16, v34
  v_add_f32 v44, v44, v76
  v_add_f32 v45, v45, v77
  s_waitcnt vmcnt(4)
  v_and_b32 v47, 0xffff0000, v35
  v_lshlrev_b32 v46, 16, v35
  v_add_f32 v46, v46, v78
  v_add_f32 v47, v47, v79
  ds_write_b128 v17, v[44:47]
  s_waitcnt vmcnt(3)
  v_and_b32 v49, 0xffff0000, v36
  v_lshlrev_b32 v48, 16, v36
  v_add_f32 v48, v48, v80
  v_add_f32 v49, v49, v81
  s_waitcnt vmcnt(2)
  v_and_b32 v51, 0xffff0000, v37
  v_lshlrev_b32 v50, 16, v37
  v_add_f32 v50, v50, v82
  v_add_f32 v51, v51, v83
  ds_write_b128 v18, v[48:51]
  s_waitcnt vmcnt(1)
  v_and_b32 v53, 0xffff0000, v38
  v_lshlrev_b32 v52, 16, v38
  v_add_f32 v52, v52, v84
  v_add_f32 v53, v53, v85
  s_waitcnt vmcnt(0)
  v_and_b32 v55, 0xffff0000, v39
  v_lshlrev_b32 v54, 16, v39
  v_add_f32 v54, v54, v86
  v_add_f32_e64 v55, v55, v87
  ds_write_b128 v19, v[52:55]
  s_waitcnt lgkmcnt(0)
L_Sfin:
  s_barrier
  ds_read_b32 v6, v236
  ds_read_b128 v[32:35], v232 offset:0
  ds_read_b128 v[36:39], v233 offset:0
  ds_read_b128 v[40:43], v232 offset:2048
  ds_read_b128 v[44:47], v233 offset:2048
  ds_read_b128 v[48:51], v232 offset:4096
  ds_read_b128 v[52:55], v233 offset:4096
  ds_read_b128 v[56:59], v232 offset:6144
  ds_read_b128 v[60:63], v233 offset:6144
  ds_read_b128 v[64:67], v234
  ds_read_b128 v[68:71], v235
  s_waitcnt lgkmcnt(6)
  v_pk_add_f32 v[32:33], v[32:33], v[40:41]
  v_pk_add_f32 v[34:35], v[34:35], v[42:43]
  v_pk_add_f32 v[36:37], v[36:37], v[44:45]
  v_pk_add_f32 v[38:39], v[38:39], v[46:47]
  s_waitcnt lgkmcnt(2)
  v_pk_add_f32 v[48:49], v[48:49], v[56:57]
  v_pk_add_f32 v[50:51], v[50:51], v[58:59]
  v_pk_add_f32 v[52:53], v[52:53], v[60:61]
  v_pk_add_f32 v[54:55], v[54:55], v[62:63]
  v_pk_add_f32 v[32:33], v[32:33], v[48:49]
  v_pk_add_f32 v[34:35], v[34:35], v[50:51]
  v_pk_add_f32 v[36:37], v[36:37], v[52:53]
  v_pk_add_f32 v[38:39], v[38:39], v[54:55]
  s_waitcnt lgkmcnt(0)
  v_pk_fma_f32 v[32:33], v[32:33], v[6:7], v[64:65] op_sel_hi:[1,0,1]
  v_pk_fma_f32 v[34:35], v[34:35], v[6:7], v[66:67] op_sel_hi:[1,0,1]
  v_pk_fma_f32 v[36:37], v[36:37], v[6:7], v[68:69] op_sel_hi:[1,0,1]
  v_pk_fma_f32 v[38:39], v[38:39], v[6:7], v[70:71] op_sel_hi:[1,0,1]
  v_cvt_pk_bf16_f32 v40, v32, v33
  v_cvt_pk_bf16_f32 v41, v34, v35
  v_cvt_pk_bf16_f32 v42, v36, v37
  v_cvt_pk_bf16_f32 v43, v38, v39
  buffer_store_dwordx4 v[40:43], v238, s[60:63], s43 offen sc1
L_exit:
  s_endpgm
L_G:
  s_mov_b32 s48, s16
  s_mov_b32 s49, s17
  s_mov_b32 s50, 2097152
  s_mov_b32 s51, 0x20000
  s_mov_b32 s56, s34
  s_mov_b32 s57, s35
  s_mov_b32 s58, 1409024
  s_mov_b32 s59, 0x20000
  s_setprio 2
  v_lshrrev_b32 v3, 3, v0
  v_lshrrev_b32 v241, 4, v0
  v_and_b32 v240, 7, v0
  v_xor_b32 v240, v240, v241
  v_lshlrev_b32 v240, 4, v240
  v_lshl_add_u32 v240, v3, 10, v240
  v_xor_b32_e64 v241, 64, v240
  v_add_u32 v241, 7168, v241
  v_add_u32 v242, 14336, v240
  v_add_u32 v243, 14336, v241
  s_lshl_b32 s85, s6, 2
  s_add_u32 s85, s85, s42
  s_lshl_b32 s85, s85, 15
  s_lshl_b32 s87, s42, 13
  s_add_u32 s87, s87, 25984
  s_cmp_eq_u32 s42, 3
  s_cselect_b32 s87, 148992, s87
  s_sub_u32 s52, s32, 2048
  s_subb_u32 s53, s33, 0
  s_mov_b32 s54, 1411072
  s_mov_b32 s55, 0x20000
  v_lshrrev_b32_e64 v244, 2, v0
  v_mul_u32_u24 v244, 2752, v244
  v_and_b32_e64 v3, 3, v0
  v_lshl_add_u32 v246, v3, 4, v244
  v_add_u32 v244, 2048, v246
  v_add_u32 v245, 1088, v246
  v_add_u32 v246, 128, v246
  s_and_b32 s15, s5, 3
  s_lshl_b32 s15, s15, 1
  s_add_u32 s84, s15, s7
  s_mul_i32 s86, s42, 44032
  s_lshl_b32 s15, s12, 6
  s_add_u32 s86, s86, s15
  s_mul_i32 s78, s42, 3072
  s_add_u32 s78, s78, 87552
  s_lshl_b32 s15, s9, 9
  s_lshl_b32 s77, s42, 7
  s_add_u32 s15, s15, s77
  v_lshl_add_u32 v17, v0, 1, s15
  s_lshl_b32 s15, s9, 2
  v_mov_b32 v18, s15
  global_load_ushort v20, v17, s[18:19]
  global_load_dword v24, v18, s[26:27]
  global_load_ushort v21, v17, s[20:21]
  s_cmp_eq_u32 s13, 3
  s_cbranch_scc1 L_G3t
  s_barrier
  s_add_u32 s77, s84, 0
  s_and_b32 s77, s77, 7
  s_lshl_b32 s77, s77, 7
  s_add_u32 m0, s87, 0
  s_add_u32 s77, s77, s85
  buffer_load_dwordx4 v240, s[48:51], s77 offen offset:0 lds
  buffer_load_dwordx4 v241, s[48:51], s77 offen offset:1024 lds
  buffer_load_dwordx4 v242, s[48:51], s77 offen offset:2048 lds
  buffer_load_dwordx4 v243, s[48:51], s77 offen offset:3072 lds
  s_add_u32 s79, s84, 0
  s_and_b32 s79, s79, 7
  s_mul_i32 s79, s79, 176128
  s_add_u32 m0, s78, 24576
  s_add_u32 s79, s79, s86
  buffer_load_dwordx4 v244, s[52:55], s79 offen offset:0 lds
  buffer_load_dwordx4 v245, s[52:55], s79 offen offset:1024 lds
  s_add_u32 s79, s84, 1
  s_and_b32 s79, s79, 7
  s_mul_i32 s79, s79, 176128
  s_add_u32 m0, s78, 36864
  s_add_u32 s79, s79, s86
  buffer_load_dwordx4 v244, s[52:55], s79 offen offset:0 lds
  buffer_load_dwordx4 v245, s[52:55], s79 offen offset:1024 lds
  s_add_u32 s15, s84, 2
  s_and_b32 s15, s15, 7
  s_lshl_b32 s18, s15, 7
  s_add_u32 s18, s18, s85
  s_mul_i32 s26, s15, 176128
  s_add_u32 s26, s26, s86
  s_add_u32 s15, s84, 3
  s_and_b32 s15, s15, 7
  s_lshl_b32 s19, s15, 7
  s_add_u32 s19, s19, s85
  s_mul_i32 s27, s15, 176128
  s_add_u32 s27, s27, s86
  s_add_u32 s15, s84, 4
  s_and_b32 s15, s15, 7
  s_lshl_b32 s20, s15, 7
  s_add_u32 s20, s20, s85
  s_mul_i32 s28, s15, 176128
  s_add_u32 s28, s28, s86
  s_add_u32 s15, s84, 5
  s_and_b32 s15, s15, 7
  s_lshl_b32 s21, s15, 7
  s_add_u32 s21, s21, s85
  s_mul_i32 s29, s15, 176128
  s_add_u32 s29, s29, s86
  s_add_u32 s15, s84, 6
  s_and_b32 s15, s15, 7
  s_lshl_b32 s22, s15, 7
  s_add_u32 s22, s22, s85
  s_mul_i32 s30, s15, 176128
  s_add_u32 s30, s30, s86
  s_add_u32 s15, s84, 7
  s_and_b32 s15, s15, 7
  s_lshl_b32 s23, s15, 7
  s_add_u32 s23, s23, s85
  s_mul_i32 s31, s15, 176128
  s_add_u32 s31, s31, s86
  v_and_b32 v3, 3, v0
  v_lshrrev_b32 v10, 5, v0
  v_lshlrev_b32_e64 v10, 9, v10
  v_bfe_u32 v11, v0, 2, 2
  v_lshl_add_u32 v10, v11, 6, v10
  v_bfe_u32 v11, v0, 4, 1
  v_lshl_add_u32 v10, v11, 5, v10
  v_lshl_add_u32 v10, v3, 3, v10
  s_xor_b32 s15, s42, 3
  s_mul_i32 s15, s15, 3072
  s_add_u32 s15, s15, 87552
  v_add_u32_e64 v13, s15, v10
  s_xor_b32 s15, s42, 2
  s_mul_i32 s15, s15, 3072
  s_add_u32 s15, s15, 87552
  v_add_u32 v12, s15, v10
  s_xor_b32 s15, s42, 1
  s_mul_i32 s15, s15, 3072
  s_add_u32 s15, s15, 87552
  v_add_u32 v11, s15, v10
  s_xor_b32 s15, s42, 0
  s_mul_i32 s15, s15, 3072
  s_add_u32 s15, s15, 87552
  v_add_u32_e64 v10, s15, v10
  v_bfe_u32 v3, v0, 1, 3
  v_lshrrev_b32 v224, 5, v0
  v_xor_b32 v3, v3, v224
  v_lshlrev_b32 v3, 4, v3
  v_and_b32 v224, 31, v0
  v_lshl_add_u32 v3, v224, 7, v3
  v_add_u32 v3, s87, v3
  s_xor_b32 s15, s42, 0
  s_lshl_b32 s15, s15, 5
  v_xor_b32 v224, s15, v3
  s_xor_b32 s15, s42, 1
  s_lshl_b32 s15, s15, 5
  v_xor_b32 v225, s15, v3
  s_xor_b32 s15, s42, 2
  s_lshl_b32 s15, s15, 5
  v_xor_b32 v226, s15, v3
  s_xor_b32 s15, s42, 3
  s_lshl_b32 s15, s15, 5
  v_xor_b32 v227, s15, v3
  v_and_b32 v3, 15, v0
  v_bfe_u32 v232, v0, 4, 1
  v_cmp_eq_u32 vcc, v3, v232
  v_mov_b32 v3, 0x3f803f80
  s_nop 0
  v_cndmask_b32 v232, 0, v3, vcc
  v_cndmask_b32 v233, 0, v3, vcc
  v_cndmask_b32 v234, 0, v3, vcc
  v_cndmask_b32 v235, 0, v3, vcc
  v_lshlrev_b32_e64 v4, 4, v0
  v_bfe_u32 v3, v0, 1, 2
  v_lshlrev_b32_e64 v228, 4, v3
  v_bfe_u32 v3, v0, 3, 2
  v_lshl_add_u32 v228, v3, 7, v228
  s_lshr_b32 s93, s85, 6
  s_add_u32 s93, s93, 12976128
  v_lshrrev_b32 v8, 3, v0
  v_lshlrev_b32_e64 v8, 10, v8
  v_bfe_u32 v3, v0, 4, 1
  v_lshlrev_b32 v3, 2, v3
  v_and_b32 v14, 7, v0
  v_xor_b32_e64 v3, v3, v14
  v_lshl_add_u32 v8, v3, 4, v8
  v_add_u32 v9, 7168, v8
  s_mul_i32 s15, s10, 0
  s_mul_i32 s91, s11, 0
  s_add_u32 s15, s15, s91
  s_and_b32 s15, s15, 7
  s_mul_i32 s15, s15, 11
  s_lshr_b32 s15, s15, 2
  s_sub_u32 s89, 22, s15
  s_mul_i32 s91, s42, 22
  s_add_u32 s91, s91, s15
  s_lshl_b32 s88, s91, 14
  s_lshl_b32 s91, s91, 10
  s_lshl_b32 s15, s11, 7
  s_add_u32 s88, s88, s15
  s_sub_u32 s94, s88, 360448
  s_sub_u32 s95, s91, 22528
  s_lshl_b32 s90, s42, 11
  s_add_u32 s90, s90, 50688
  v_and_b32 v14, 31, v0
  v_lshlrev_b32 v14, 5, v14
  v_lshrrev_b32 v3, 5, v0
  v_lshl_add_u32 v229, v3, 4, v14
  s_lshl_b32 s15, s42, 3
  s_add_u32 s15, s15, 157184
  v_add_u32_e64 v14, s15, v14
  v_add_u32 v229, 157184, v229
  v_lshrrev_b32 v238, 5, v0
  v_lshlrev_b32 v238, 9, v238
  v_bfe_u32 v3, v0, 2, 2
  v_lshl_add_u32 v238, v3, 7, v238
  v_bfe_u32 v3, v0, 3, 1
  v_lshl_add_u32 v238, v3, 6, v238
  v_and_b32_e64 v3, 1, v0
  v_lshl_add_u32 v238, v3, 5, v238
  v_bfe_u32 v3, v0, 4, 1
  v_lshl_add_u32 v238, v3, 4, v238
  v_bfe_u32 v3, v0, 1, 1
  v_lshl_add_u32 v238, v3, 3, v238
  v_xor_b32 v239, 64, v238
  v_add_u32 v238, s90, v238
  v_add_u32_e64 v239, s90, v239
  s_lshr_b32 s64, s85, 15
  s_lshr_b32 s66, s64, 1
  s_lshl_b32 s66, s66, 9
  s_and_b32 s15, s64, 1
  s_lshl_b32 s15, s15, 2
  s_add_u32 s66, s66, s15
  s_mul_i32 s64, s64, 88064
  s_lshl_b32 s15, s12, 11
  s_add_u32 s64, s64, s15
  s_add_u32 s64, s64, 4194304
  s_add_u32 s65, s64, 4096
  s_add_u32 s66, s66, 12713984
  s_and_b32 s15, s7, 3
  s_lshl_b32 s15, s15, 3
  s_lshr_b32 s98, s7, 2
  s_lshl_b32 s98, s98, 7
  s_add_u32 s67, s98, 128
  s_add_u32 s67, s67, s66
  s_add_u32 s98, s98, s15
  s_bfe_u32 s15, s7, 0x10002
  s_lshl_b32 s15, s15, 3
  s_add_u32 s98, s98, s15
  s_add_u32 s66, s66, s98
  ds_write_b32 v14, v1 offset:4
  ds_write_b32 v14, v1 offset:1028
  s_lshl_b32 s96, s42, 13
  s_add_u32 s96, s96, 50688
  v_lshlrev_b32 v25, 7, v0
  v_and_b32 v26, 7, v0
  v_lshl_add_u32 v25, v26, 4, v25
  v_xor_b32 v200, 0, v25
  v_add_u32 v200, s96, v200
  v_xor_b32 v201, 16, v25
  v_add_u32 v201, s96, v201
  v_xor_b32 v202, 32, v25
  v_add_u32 v202, s96, v202
  v_xor_b32 v203, 48, v25
  v_add_u32 v203, s96, v203
  v_xor_b32 v204, 64, v25
  v_add_u32 v204, s96, v204
  v_xor_b32 v205, 80, v25
  v_add_u32_e64 v205, s96, v205
  v_xor_b32 v206, 96, v25
  v_add_u32_e64 v206, s96, v206
  v_xor_b32 v207, 112, v25
  v_add_u32 v207, s96, v207
  s_lshl_b32 s15, s42, 2
  v_mov_b32 v210, s15
  s_waitcnt vmcnt(8)
  s_mov_b32 s60, 0x3fb8aa3b
  s_lshr_b32 s15, s42, 1
  s_lshl_b32 s15, s15, 4
  v_lshrrev_b32 v24, s15, v24
  v_lshlrev_b32 v24, 16, v24
  v_lshlrev_b32 v20, 16, v20
  v_lshlrev_b32 v21, 16, v21
  v_mul_f32 v29, 0x3fb8aa3b, v24
  v_fma_f32 v30, v24, s60, -v29
  v_fmac_f32 v30, 0x32a5705f, v24
  v_exp_f32_e64 v28, v29
  v_mul_f32 v30, 0x3f317218, v30
  v_fmac_f32_e64 v28, v28, v30
  v_cvt_pk_bf16_f32 v28, v28, v28
  v_lshlrev_b32_e64 v28, 16, v28
  v_mul_f32 v29, 0x3fb8aa3b, v20
  v_fma_f32 v30, v20, s60, -v29
  v_fmac_f32 v30, 0x32a5705f, v20
  v_exp_f32_e64 v31, v29
  v_mul_f32 v30, 0x3f317218, v30
  v_fmac_f32_e64 v31, v31, v30
  v_cvt_pk_bf16_f32 v31, v31, v31
  v_lshlrev_b32 v31, 16, v31
  v_mul_f32 v20, v31, v28
  v_mul_f32_e64 v21, v21, v28
  v_mul_f32 v20, 0xbfb8aa3b, v20
  v_mul_f32_e64 v21, 0x3e22f983, v21
  v_mul_f32 v60, 0x41000000, v20
  v_mul_f32 v61, 0x41000000, v21
  v_exp_f32 v60, v60
  v_fract_f32 v61, v61
  v_cos_f32 v34, v61
  v_sin_f32 v35, v61
  v_mul_f32 v62, 0x42000000, v20
  v_mul_f32 v63, 0x42000000, v21
  v_exp_f32 v62, v62
  v_fract_f32 v63, v63
  v_cos_f32 v50, v63
  v_sin_f32 v51, v63
  v_mul_f32 v56, 0x41800000, v20
  v_mul_f32 v57, 0x41800000, v21
  v_exp_f32 v56, v56
  v_fract_f32 v57, v57
  v_cos_f32 v36, v57
  v_sin_f32 v37, v57
  v_pk_mul_f32 v[34:35], v[34:35], v[60:61] op_sel_hi:[1,0]
  v_pk_mul_f32 v[50:51], v[50:51], v[62:63] op_sel_hi:[1,0]
  v_pk_mul_f32 v[36:37], v[36:37], v[56:57] op_sel_hi:[1,0]
  v_mov_b32 v32, 1.0
  v_mov_b32 v33, 0
  v_mov_b32 v48, v35
  v_mov_b32 v52, v51
  v_pk_mul_f32 v[38:39], v[36:37], v[34:35] op_sel_hi:[1,0]
  v_pk_fma_f32 v[38:39], v[36:37], v[48:49], v[38:39] op_sel:[1,0,0] op_sel_hi:[0,0,1] neg_lo:[1,0,0]
  v_pk_mul_f32 v[40:41], v[32:33], v[50:51] op_sel_hi:[1,0]
  v_pk_mul_f32 v[42:43], v[34:35], v[50:51] op_sel_hi:[1,0]
  v_pk_mul_f32 v[44:45], v[36:37], v[50:51] op_sel_hi:[1,0]
  v_pk_mul_f32 v[46:47], v[38:39], v[50:51] op_sel_hi:[1,0]
  v_pk_fma_f32 v[40:41], v[32:33], v[52:53], v[40:41] op_sel:[1,0,0] op_sel_hi:[0,0,1] neg_lo:[1,0,0]
  v_pk_fma_f32 v[42:43], v[34:35], v[52:53], v[42:43] op_sel:[1,0,0] op_sel_hi:[0,0,1] neg_lo:[1,0,0]
  v_pk_fma_f32 v[44:45], v[36:37], v[52:53], v[44:45] op_sel:[1,0,0] op_sel_hi:[0,0,1] neg_lo:[1,0,0]
  v_pk_fma_f32 v[46:47], v[38:39], v[52:53], v[46:47] op_sel:[1,0,0] op_sel_hi:[0,0,1] neg_lo:[1,0,0]
  v_cvt_pk_bf16_f32 v136, v32, v34
  v_cvt_pk_bf16_f32 v152, v33, v35
  v_cvt_pk_bf16_f32 v137, v36, v38
  v_cvt_pk_bf16_f32 v153, v37, v39
  v_pk_mul_f32 v[32:33], v[40:41], v[50:51] op_sel_hi:[1,0]
  v_pk_mul_f32 v[34:35], v[42:43], v[50:51] op_sel_hi:[1,0]
  v_pk_mul_f32 v[36:37], v[44:45], v[50:51] op_sel_hi:[1,0]
  v_pk_mul_f32 v[38:39], v[46:47], v[50:51] op_sel_hi:[1,0]
  v_pk_fma_f32 v[32:33], v[40:41], v[52:53], v[32:33] op_sel:[1,0,0] op_sel_hi:[0,0,1] neg_lo:[1,0,0]
  v_pk_fma_f32 v[34:35], v[42:43], v[52:53], v[34:35] op_sel:[1,0,0] op_sel_hi:[0,0,1] neg_lo:[1,0,0]
  v_pk_fma_f32 v[36:37], v[44:45], v[52:53], v[36:37] op_sel:[1,0,0] op_sel_hi:[0,0,1] neg_lo:[1,0,0]
  v_pk_fma_f32 v[38:39], v[46:47], v[52:53], v[38:39] op_sel:[1,0,0] op_sel_hi:[0,0,1] neg_lo:[1,0,0]
  v_cvt_pk_bf16_f32 v138, v40, v42
  v_cvt_pk_bf16_f32 v154, v41, v43
  v_cvt_pk_bf16_f32 v139, v44, v46
  v_cvt_pk_bf16_f32 v155, v45, v47
  v_pk_mul_f32 v[40:41], v[32:33], v[50:51] op_sel_hi:[1,0]
  v_pk_mul_f32 v[42:43], v[34:35], v[50:51] op_sel_hi:[1,0]
  v_pk_mul_f32 v[44:45], v[36:37], v[50:51] op_sel_hi:[1,0]
  v_pk_mul_f32 v[46:47], v[38:39], v[50:51] op_sel_hi:[1,0]
  v_pk_fma_f32 v[40:41], v[32:33], v[52:53], v[40:41] op_sel:[1,0,0] op_sel_hi:[0,0,1] neg_lo:[1,0,0]
  v_pk_fma_f32 v[42:43], v[34:35], v[52:53], v[42:43] op_sel:[1,0,0] op_sel_hi:[0,0,1] neg_lo:[1,0,0]
  v_pk_fma_f32 v[44:45], v[36:37], v[52:53], v[44:45] op_sel:[1,0,0] op_sel_hi:[0,0,1] neg_lo:[1,0,0]
  v_pk_fma_f32 v[46:47], v[38:39], v[52:53], v[46:47] op_sel:[1,0,0] op_sel_hi:[0,0,1] neg_lo:[1,0,0]
  v_cvt_pk_bf16_f32 v140, v32, v34
  v_cvt_pk_bf16_f32 v156, v33, v35
  v_cvt_pk_bf16_f32 v141, v36, v38
  v_cvt_pk_bf16_f32 v157, v37, v39
  v_pk_mul_f32 v[32:33], v[40:41], v[50:51] op_sel_hi:[1,0]
  v_pk_mul_f32 v[34:35], v[42:43], v[50:51] op_sel_hi:[1,0]
  v_pk_mul_f32 v[36:37], v[44:45], v[50:51] op_sel_hi:[1,0]
  v_pk_mul_f32 v[38:39], v[46:47], v[50:51] op_sel_hi:[1,0]
  v_pk_fma_f32 v[32:33], v[40:41], v[52:53], v[32:33] op_sel:[1,0,0] op_sel_hi:[0,0,1] neg_lo:[1,0,0]
  v_pk_fma_f32 v[34:35], v[42:43], v[52:53], v[34:35] op_sel:[1,0,0] op_sel_hi:[0,0,1] neg_lo:[1,0,0]
  v_pk_fma_f32 v[36:37], v[44:45], v[52:53], v[36:37] op_sel:[1,0,0] op_sel_hi:[0,0,1] neg_lo:[1,0,0]
  v_pk_fma_f32 v[38:39], v[46:47], v[52:53], v[38:39] op_sel:[1,0,0] op_sel_hi:[0,0,1] neg_lo:[1,0,0]
  v_cvt_pk_bf16_f32 v142, v40, v42
  v_cvt_pk_bf16_f32 v158, v41, v43
  v_cvt_pk_bf16_f32 v143, v44, v46
  v_cvt_pk_bf16_f32 v159, v45, v47
  v_pk_mul_f32 v[40:41], v[32:33], v[50:51] op_sel_hi:[1,0]
  v_pk_mul_f32 v[42:43], v[34:35], v[50:51] op_sel_hi:[1,0]
  v_pk_mul_f32 v[44:45], v[36:37], v[50:51] op_sel_hi:[1,0]
  v_pk_mul_f32 v[46:47], v[38:39], v[50:51] op_sel_hi:[1,0]
  v_pk_fma_f32 v[40:41], v[32:33], v[52:53], v[40:41] op_sel:[1,0,0] op_sel_hi:[0,0,1] neg_lo:[1,0,0]
  v_pk_fma_f32 v[42:43], v[34:35], v[52:53], v[42:43] op_sel:[1,0,0] op_sel_hi:[0,0,1] neg_lo:[1,0,0]
  v_pk_fma_f32 v[44:45], v[36:37], v[52:53], v[44:45] op_sel:[1,0,0] op_sel_hi:[0,0,1] neg_lo:[1,0,0]
  v_pk_fma_f32 v[46:47], v[38:39], v[52:53], v[46:47] op_sel:[1,0,0] op_sel_hi:[0,0,1] neg_lo:[1,0,0]
  v_cvt_pk_bf16_f32 v144, v32, v34
  v_cvt_pk_bf16_f32 v160, v33, v35
  v_cvt_pk_bf16_f32 v145, v36, v38
  v_cvt_pk_bf16_f32 v161, v37, v39
  v_pk_mul_f32 v[32:33], v[40:41], v[50:51] op_sel_hi:[1,0]
  v_pk_mul_f32 v[34:35], v[42:43], v[50:51] op_sel_hi:[1,0]
  v_pk_mul_f32 v[36:37], v[44:45], v[50:51] op_sel_hi:[1,0]
  v_pk_mul_f32 v[38:39], v[46:47], v[50:51] op_sel_hi:[1,0]
  v_pk_fma_f32 v[32:33], v[40:41], v[52:53], v[32:33] op_sel:[1,0,0] op_sel_hi:[0,0,1] neg_lo:[1,0,0]
  v_pk_fma_f32 v[34:35], v[42:43], v[52:53], v[34:35] op_sel:[1,0,0] op_sel_hi:[0,0,1] neg_lo:[1,0,0]
  v_pk_fma_f32 v[36:37], v[44:45], v[52:53], v[36:37] op_sel:[1,0,0] op_sel_hi:[0,0,1] neg_lo:[1,0,0]
  v_pk_fma_f32 v[38:39], v[46:47], v[52:53], v[38:39] op_sel:[1,0,0] op_sel_hi:[0,0,1] neg_lo:[1,0,0]
  v_cvt_pk_bf16_f32 v146, v40, v42
  v_cvt_pk_bf16_f32 v162, v41, v43
  v_cvt_pk_bf16_f32 v147, v44, v46
  v_cvt_pk_bf16_f32 v163, v45, v47
  v_pk_mul_f32 v[40:41], v[32:33], v[50:51] op_sel_hi:[1,0]
  v_pk_mul_f32 v[42:43], v[34:35], v[50:51] op_sel_hi:[1,0]
  v_pk_mul_f32 v[44:45], v[36:37], v[50:51] op_sel_hi:[1,0]
  v_pk_mul_f32 v[46:47], v[38:39], v[50:51] op_sel_hi:[1,0]
  v_pk_fma_f32 v[40:41], v[32:33], v[52:53], v[40:41] op_sel:[1,0,0] op_sel_hi:[0,0,1] neg_lo:[1,0,0]
  v_pk_fma_f32 v[42:43], v[34:35], v[52:53], v[42:43] op_sel:[1,0,0] op_sel_hi:[0,0,1] neg_lo:[1,0,0]
  v_pk_fma_f32 v[44:45], v[36:37], v[52:53], v[44:45] op_sel:[1,0,0] op_sel_hi:[0,0,1] neg_lo:[1,0,0]
  v_pk_fma_f32 v[46:47], v[38:39], v[52:53], v[46:47] op_sel:[1,0,0] op_sel_hi:[0,0,1] neg_lo:[1,0,0]
  v_cvt_pk_bf16_f32 v148, v32, v34
  v_cvt_pk_bf16_f32 v164, v33, v35
  v_cvt_pk_bf16_f32 v149, v36, v38
  v_cvt_pk_bf16_f32 v165, v37, v39
  s_add_u32 s77, s84, 1
  s_and_b32 s77, s77, 7
  s_lshl_b32 s77, s77, 7
  s_add_u32 m0, s87, 4096
  s_add_u32 s77, s77, s85
  buffer_load_dwordx4 v240, s[48:51], s77 offen offset:0 lds
  buffer_load_dwordx4 v241, s[48:51], s77 offen offset:1024 lds
  buffer_load_dwordx4 v242, s[48:51], s77 offen offset:2048 lds
  buffer_load_dwordx4 v243, s[48:51], s77 offen offset:3072 lds
  s_add_u32 s79, s84, 2
  s_and_b32 s79, s79, 7
  s_mul_i32 s79, s79, 176128
  s_add_u32 m0, s78, 49152
  s_add_u32 s79, s79, s86
  buffer_load_dwordx4 v244, s[52:55], s79 offen offset:0 lds
  buffer_load_dwordx4 v245, s[52:55], s79 offen offset:1024 lds
  v_cvt_pk_bf16_f32 v150, v40, v42
  v_cvt_pk_bf16_f32 v166, v41, v43
  v_cvt_pk_bf16_f32 v151, v44, v46
  v_cvt_pk_bf16_f32 v167, v45, v47
  ds_write_b128 v200, v[136:139]
  ds_write_b128 v201, v[140:143]
  ds_write_b128 v202, v[144:147]
  ds_write_b128 v203, v[148:151]
  ds_write_b128 v204, v[152:155]
  ds_write_b128 v205, v[156:159]
  ds_write_b128 v206, v[160:163]
  ds_write_b128 v207, v[164:167]
  s_mov_b64 exec, 1
  ds_add_u32 v210, v2 offset:68
  s_mov_b64 exec, -1
  s_lshr_b32 s15, s5, 2
  s_cmp_lg_u32 s15, 6
  s_cbranch_scc1 L_npg
  s_sub_u32 s15, s2, 192
  s_mul_i32 s15, s15, 44032
  s_mul_i32 s98, s42, 11008
  s_add_u32 s98, s98, s15
  v_lshlrev_b32 v3, 7, v0
  s_add_u32 s99, s98, 8192
  buffer_load_dword v174, v3, s[56:59], s98 offen
  s_mov_b64 exec, 0x3fffff
  buffer_load_dword v175, v3, s[56:59], s99 offen
  s_mov_b64 exec, -1
L_npg:
  s_waitcnt vmcnt(8)
  s_mov_b64 exec, 1
  ds_add_u32 v1, v2 offset:32
  s_mov_b64 exec, -1
  ds_read_b128 v[128:131], v224 offset:0
  ds_read_b128 v[132:135], v225 offset:0
  ds_read_b128 v[136:139], v226 offset:0
  ds_read_b128 v[140:143], v227 offset:0
  ds_read_b32 v3, v1 offset:32
  s_waitcnt lgkmcnt(0)
  v_readfirstlane_b32 s15, v3
  s_nop 0
  s_cmp_ge_u32 s15, 4
  s_cbranch_scc1 L_lwd_40
L_lw_39:
  s_sleep 1
  ds_read_b32 v3, v1 offset:32
  s_sub_u32 s76, s76, 1
  s_waitcnt lgkmcnt(0)
  v_readfirstlane_b32 s15, v3
  s_cmp_lt_i32 s76, 0
  s_cselect_b32 s15, 4, s15
  s_cmp_ge_u32 s15, 4
  s_cbranch_scc0 L_lw_39
L_lwd_40:
  ds_read_b64_tr_b16 v[44:45], v10 offset:24576
  ds_read_b64_tr_b16 v[46:47], v10 offset:24832
  ds_read_b64_tr_b16 v[48:49], v10 offset:25600
  ds_read_b64_tr_b16 v[50:51], v10 offset:25856
  ds_read_b64_tr_b16 v[56:57], v11 offset:24576
  ds_read_b64_tr_b16 v[58:59], v11 offset:24832
  ds_read_b64_tr_b16 v[60:61], v11 offset:25600
  ds_read_b64_tr_b16 v[62:63], v11 offset:25856
  s_waitcnt vmcnt(2)
  s_mov_b64 exec, 1
  ds_add_u32 v1, v2 offset:36
  s_mov_b64 exec, -1
  ds_read_b128 v[144:147], v224 offset:4096
  ds_read_b128 v[148:151], v225 offset:4096
  ds_read_b128 v[152:155], v226 offset:4096
  ds_read_b128 v[156:159], v227 offset:4096
  s_waitcnt lgkmcnt(9)
  v_mfma_f32_32x32x16_bf16 v[80:95], v[44:47], v[128:131], 0
  ds_read_b64_tr_b16 v[68:69], v12 offset:24576
  ds_read_b64_tr_b16 v[70:71], v12 offset:24832
  v_mfma_f32_16x16x32_bf16 v[184:187], v[232:235], v[44:47], 0
  s_add_u32 m0, s87, 0
  s_nop 0
  buffer_load_dwordx4 v240, s[48:51], s18 offen offset:0 lds
  buffer_load_dwordx4 v241, s[48:51], s18 offen offset:1024 lds
  v_mfma_f32_32x32x16_bf16 v[96:111], v[48:51], v[128:131], 0
  ds_read_b64_tr_b16 v[72:73], v12 offset:25600
  ds_read_b64_tr_b16 v[74:75], v12 offset:25856
  buffer_load_dwordx4 v242, s[48:51], s18 offen offset:2048 lds
  s_waitcnt lgkmcnt(4)
  ds_read_b32 v173, v1 offset:36
  v_mfma_f32_32x32x16_bf16 v[80:95], v[56:59], v[132:135], v[80:95]
  ds_read_b64_tr_b16 v[44:45], v13 offset:24576
  ds_read_b64_tr_b16 v[46:47], v13 offset:24832
  v_mfma_f32_16x16x32_bf16 v[188:191], v[232:235], v[60:63], 0
  buffer_load_dwordx4 v243, s[48:51], s18 offen offset:3072 lds
  v_mfma_f32_32x32x16_bf16 v[96:111], v[60:63], v[132:135], v[96:111]
  ds_read_b64_tr_b16 v[48:49], v13 offset:25600
  ds_read_b64_tr_b16 v[50:51], v13 offset:25856
  s_add_u32 m0, s78, 0
  s_nop 0
  buffer_load_dwordx4 v244, s[52:55], s27 offen offset:0 lds
  s_waitcnt lgkmcnt(4)
  v_readfirstlane_b32 s15, v173
  s_nop 0
  s_cmp_ge_u32 s15, 4
  s_cbranch_scc1 L_lwd_42
L_lw_41:
  s_sleep 1
  ds_read_b32 v173, v1 offset:36
  s_sub_u32 s76, s76, 1
  s_waitcnt lgkmcnt(0)
  v_readfirstlane_b32 s15, v173
  s_cmp_lt_i32 s76, 0
  s_cselect_b32 s15, 4, s15
  s_cmp_ge_u32 s15, 4
  s_cbranch_scc0 L_lw_41
L_lwd_42:
  v_mfma_f32_32x32x16_bf16 v[80:95], v[68:71], v[136:139], v[80:95]
  ds_read_b64_tr_b16 v[56:57], v10 offset:36864
  ds_read_b64_tr_b16 v[58:59], v10 offset:37120
  buffer_load_dwordx4 v245, s[52:55], s27 offen offset:1024 lds
  s_add_u32 m0, s87, 4096
  s_nop 0
  buffer_load_dwordx4 v240, s[48:51], s19 offen offset:0 lds
  v_mfma_f32_32x32x16_bf16 v[96:111], v[72:75], v[136:139], v[96:111]
  ds_read_b64_tr_b16 v[60:61], v10 offset:37888
  ds_read_b64_tr_b16 v[62:63], v10 offset:38144
  buffer_load_dwordx4 v241, s[48:51], s19 offen offset:1024 lds
  s_waitcnt lgkmcnt(4)
  v_mfma_f32_32x32x16_bf16 v[80:95], v[44:47], v[140:143], v[80:95]
  ds_read_b64_tr_b16 v[68:69], v11 offset:36864
  ds_read_b64_tr_b16 v[70:71], v11 offset:37120
  buffer_load_dwordx4 v242, s[48:51], s19 offen offset:2048 lds
  v_mfma_f32_32x32x16_bf16 v[96:111], v[48:51], v[140:143], v[96:111]
  ds_read_b64_tr_b16 v[72:73], v11 offset:37888
  ds_read_b64_tr_b16 v[74:75], v11 offset:38144
  buffer_load_dwordx4 v243, s[48:51], s19 offen offset:3072 lds
  s_waitcnt vmcnt(6)
  s_mov_b64 exec, 1
  ds_add_u32 v1, v2 offset:40
  s_mov_b64 exec, -1
  ds_read_b128 v[128:131], v224 offset:0
  ds_read_b128 v[132:135], v225 offset:0
  ds_read_b128 v[136:139], v226 offset:0
  ds_read_b128 v[140:143], v227 offset:0
  s_waitcnt lgkmcnt(9)
  v_mfma_f32_32x32x16_bf16 v[80:95], v[56:59], v[144:147], v[80:95]
  ds_read_b64_tr_b16 v[44:45], v12 offset:36864
  ds_read_b64_tr_b16 v[46:47], v12 offset:37120
  v_mfma_f32_16x16x32_bf16 v[184:187], v[232:235], v[56:59], v[184:187]
  s_add_u32 m0, s78, 12288
  s_nop 0
  buffer_load_dwordx4 v244, s[52:55], s28 offen offset:0 lds
  v_mfma_f32_32x32x16_bf16 v[96:111], v[60:63], v[144:147], v[96:111]
  ds_read_b64_tr_b16 v[48:49], v12 offset:37888
  ds_read_b64_tr_b16 v[50:51], v12 offset:38144
  buffer_load_dwordx4 v245, s[52:55], s28 offen offset:1024 lds
  s_waitcnt lgkmcnt(4)
  ds_read_b32 v173, v1 offset:40
  v_mfma_f32_32x32x16_bf16 v[80:95], v[68:71], v[148:151], v[80:95]
  ds_read_b64_tr_b16 v[56:57], v13 offset:36864
  ds_read_b64_tr_b16 v[58:59], v13 offset:37120
  v_mfma_f32_16x16x32_bf16 v[188:191], v[232:235], v[72:75], v[188:191]
  s_add_u32 m0, s87, 0
  s_nop 0
  buffer_load_dwordx4 v240, s[48:51], s20 offen offset:0 lds
  v_mfma_f32_32x32x16_bf16 v[96:111], v[72:75], v[148:151], v[96:111]
  ds_read_b64_tr_b16 v[60:61], v13 offset:37888
  ds_read_b64_tr_b16 v[62:63], v13 offset:38144
  s_waitcnt lgkmcnt(4)
  v_readfirstlane_b32 s15, v173
  s_nop 0
  s_cmp_ge_u32 s15, 4
  s_cbranch_scc1 L_lwd_44
L_lw_43:
  s_sleep 1
  ds_read_b32 v173, v1 offset:40
  s_sub_u32 s76, s76, 1
  s_waitcnt lgkmcnt(0)
  v_readfirstlane_b32 s15, v173
  s_cmp_lt_i32 s76, 0
  s_cselect_b32 s15, 4, s15
  s_cmp_ge_u32 s15, 4
  s_cbranch_scc0 L_lw_43
L_lwd_44:
  v_mfma_f32_32x32x16_bf16 v[80:95], v[44:47], v[152:155], v[80:95]
  ds_read_b64_tr_b16 v[68:69], v10 offset:49152
  ds_read_b64_tr_b16 v[70:71], v10 offset:49408
  buffer_load_dwordx4 v241, s[48:51], s20 offen offset:1024 lds
  v_mfma_f32_32x32x16_bf16 v[96:111], v[48:51], v[152:155], v[96:111]
  ds_read_b64_tr_b16 v[72:73], v10 offset:50176
  ds_read_b64_tr_b16 v[74:75], v10 offset:50432
  buffer_load_dwordx4 v242, s[48:51], s20 offen offset:2048 lds
  s_waitcnt lgkmcnt(4)
  v_mfma_f32_32x32x16_bf16 v[80:95], v[56:59], v[156:159], v[80:95]
  ds_read_b64_tr_b16 v[44:45], v11 offset:49152
  ds_read_b64_tr_b16 v[46:47], v11 offset:49408
  buffer_load_dwordx4 v243, s[48:51], s20 offen offset:3072 lds
  v_mfma_f32_32x32x16_bf16 v[96:111], v[60:63], v[156:159], v[96:111]
  ds_read_b64_tr_b16 v[48:49], v11 offset:50176
  ds_read_b64_tr_b16 v[50:51], v11 offset:50432
  s_waitcnt vmcnt(6)
  s_mov_b64 exec, 1
  ds_add_u32 v1, v2 offset:44
  s_mov_b64 exec, -1
  ds_read_b128 v[144:147], v224 offset:4096
  ds_read_b128 v[148:151], v225 offset:4096
  ds_read_b128 v[152:155], v226 offset:4096
  ds_read_b128 v[156:159], v227 offset:4096
  s_waitcnt lgkmcnt(9)
  v_mfma_f32_32x32x16_bf16 v[80:95], v[68:71], v[128:131], v[80:95]
  ds_read_b64_tr_b16 v[56:57], v12 offset:49152
  ds_read_b64_tr_b16 v[58:59], v12 offset:49408
  v_mfma_f32_16x16x32_bf16 v[184:187], v[232:235], v[68:71], v[184:187]
  s_add_u32 m0, s78, 24576
  s_nop 0
  buffer_load_dwordx4 v244, s[52:55], s29 offen offset:0 lds
  v_mfma_f32_32x32x16_bf16 v[96:111], v[72:75], v[128:131], v[96:111]
  ds_read_b64_tr_b16 v[60:61], v12 offset:50176
  ds_read_b64_tr_b16 v[62:63], v12 offset:50432
  buffer_load_dwordx4 v245, s[52:55], s29 offen offset:1024 lds
  s_waitcnt lgkmcnt(4)
  ds_read_b32 v173, v1 offset:44
  v_mfma_f32_32x32x16_bf16 v[80:95], v[44:47], v[132:135], v[80:95]
  ds_read_b64_tr_b16 v[68:69], v13 offset:49152
  ds_read_b64_tr_b16 v[70:71], v13 offset:49408
  v_mfma_f32_16x16x32_bf16 v[188:191], v[232:235], v[48:51], v[188:191]
  s_add_u32 m0, s87, 4096
  s_nop 0
  buffer_load_dwordx4 v240, s[48:51], s21 offen offset:0 lds
  v_mfma_f32_32x32x16_bf16 v[96:111], v[48:51], v[132:135], v[96:111]
  ds_read_b64_tr_b16 v[72:73], v13 offset:50176
  ds_read_b64_tr_b16 v[74:75], v13 offset:50432
  s_waitcnt lgkmcnt(4)
  v_readfirstlane_b32 s15, v173
  s_nop 0
  s_cmp_ge_u32 s15, 4
  s_cbranch_scc1 L_lwd_46
L_lw_45:
  s_sleep 1
  ds_read_b32 v173, v1 offset:44
  s_sub_u32 s76, s76, 1
  s_waitcnt lgkmcnt(0)
  v_readfirstlane_b32 s15, v173
  s_cmp_lt_i32 s76, 0
  s_cselect_b32 s15, 4, s15
  s_cmp_ge_u32 s15, 4
  s_cbranch_scc0 L_lw_45
L_lwd_46:
  v_mfma_f32_32x32x16_bf16 v[80:95], v[56:59], v[136:139], v[80:95]
  ds_read_b64_tr_b16 v[44:45], v10 offset:0
  ds_read_b64_tr_b16 v[46:47], v10 offset:256
  buffer_load_dwordx4 v241, s[48:51], s21 offen offset:1024 lds
  v_mfma_f32_32x32x16_bf16 v[96:111], v[60:63], v[136:139], v[96:111]
  ds_read_b64_tr_b16 v[48:49], v10 offset:1024
  ds_read_b64_tr_b16 v[50:51], v10 offset:1280
  buffer_load_dwordx4 v242, s[48:51], s21 offen offset:2048 lds
  s_waitcnt lgkmcnt(4)
  v_mfma_f32_32x32x16_bf16 v[80:95], v[68:71], v[140:143], v[80:95]
  ds_read_b64_tr_b16 v[56:57], v11 offset:0
  ds_read_b64_tr_b16 v[58:59], v11 offset:256
  buffer_load_dwordx4 v243, s[48:51], s21 offen offset:3072 lds
  v_mfma_f32_32x32x16_bf16 v[96:111], v[72:75], v[140:143], v[96:111]
  ds_read_b64_tr_b16 v[60:61], v11 offset:1024
  ds_read_b64_tr_b16 v[62:63], v11 offset:1280
  s_waitcnt vmcnt(6)
  s_mov_b64 exec, 1
  ds_add_u32 v1, v2 offset:48
  s_mov_b64 exec, -1
  ds_read_b128 v[128:131], v224 offset:0
  ds_read_b128 v[132:135], v225 offset:0
  ds_read_b128 v[136:139], v226 offset:0
  ds_read_b128 v[140:143], v227 offset:0
  s_waitcnt lgkmcnt(9)
  v_mfma_f32_32x32x16_bf16 v[80:95], v[44:47], v[144:147], v[80:95]
  ds_read_b64_tr_b16 v[68:69], v12 offset:0
  ds_read_b64_tr_b16 v[70:71], v12 offset:256
  v_mfma_f32_16x16x32_bf16 v[184:187], v[232:235], v[44:47], v[184:187]
  s_add_u32 m0, s78, 36864
  s_nop 0
  buffer_load_dwordx4 v244, s[52:55], s30 offen offset:0 lds
  v_mfma_f32_32x32x16_bf16 v[96:111], v[48:51], v[144:147], v[96:111]
  ds_read_b64_tr_b16 v[72:73], v12 offset:1024
  ds_read_b64_tr_b16 v[74:75], v12 offset:1280
  buffer_load_dwordx4 v245, s[52:55], s30 offen offset:1024 lds
  s_waitcnt lgkmcnt(4)
  ds_read_b32 v173, v1 offset:48
  v_mfma_f32_32x32x16_bf16 v[80:95], v[56:59], v[148:151], v[80:95]
  ds_read_b64_tr_b16 v[44:45], v13 offset:0
  ds_read_b64_tr_b16 v[46:47], v13 offset:256
  v_mfma_f32_16x16x32_bf16 v[188:191], v[232:235], v[60:63], v[188:191]
  s_add_u32 m0, s87, 0
  s_nop 0
  buffer_load_dwordx4 v240, s[48:51], s22 offen offset:0 lds
  v_mfma_f32_32x32x16_bf16 v[96:111], v[60:63], v[148:151], v[96:111]
  ds_read_b64_tr_b16 v[48:49], v13 offset:1024
  ds_read_b64_tr_b16 v[50:51], v13 offset:1280
  s_waitcnt lgkmcnt(4)
  v_readfirstlane_b32 s15, v173
  s_nop 0
  s_cmp_ge_u32 s15, 4
  s_cbranch_scc1 L_lwd_48
L_lw_47:
  s_sleep 1
  ds_read_b32 v173, v1 offset:48
  s_sub_u32 s76, s76, 1
  s_waitcnt lgkmcnt(0)
  v_readfirstlane_b32 s15, v173
  s_cmp_lt_i32 s76, 0
  s_cselect_b32 s15, 4, s15
  s_cmp_ge_u32 s15, 4
  s_cbranch_scc0 L_lw_47
L_lwd_48:
  v_mfma_f32_32x32x16_bf16 v[80:95], v[68:71], v[152:155], v[80:95]
  ds_read_b64_tr_b16 v[56:57], v10 offset:12288
  ds_read_b64_tr_b16 v[58:59], v10 offset:12544
  buffer_load_dwordx4 v241, s[48:51], s22 offen offset:1024 lds
  v_mfma_f32_32x32x16_bf16 v[96:111], v[72:75], v[152:155], v[96:111]
  ds_read_b64_tr_b16 v[60:61], v10 offset:13312
  ds_read_b64_tr_b16 v[62:63], v10 offset:13568
  buffer_load_dwordx4 v242, s[48:51], s22 offen offset:2048 lds
  s_waitcnt lgkmcnt(4)
  v_mfma_f32_32x32x16_bf16 v[80:95], v[44:47], v[156:159], v[80:95]
  ds_read_b64_tr_b16 v[68:69], v11 offset:12288
  ds_read_b64_tr_b16 v[70:71], v11 offset:12544
  buffer_load_dwordx4 v243, s[48:51], s22 offen offset:3072 lds
  v_mfma_f32_32x32x16_bf16 v[96:111], v[48:51], v[156:159], v[96:111]
  ds_read_b64_tr_b16 v[72:73], v11 offset:13312
  ds_read_b64_tr_b16 v[74:75], v11 offset:13568
  s_waitcnt vmcnt(6)
  s_mov_b64 exec, 1
  ds_add_u32 v1, v2 offset:52
  s_mov_b64 exec, -1
  ds_read_b128 v[144:147], v224 offset:4096
  ds_read_b128 v[148:151], v225 offset:4096
  ds_read_b128 v[152:155], v226 offset:4096
  ds_read_b128 v[156:159], v227 offset:4096
  s_waitcnt lgkmcnt(9)
  v_mfma_f32_32x32x16_bf16 v[80:95], v[56:59], v[128:131], v[80:95]
  ds_read_b64_tr_b16 v[44:45], v12 offset:12288
  ds_read_b64_tr_b16 v[46:47], v12 offset:12544
  v_mfma_f32_16x16x32_bf16 v[184:187], v[232:235], v[56:59], v[184:187]
  s_add_u32 m0, s78, 49152
  s_nop 0
  buffer_load_dwordx4 v244, s[52:55], s31 offen offset:0 lds
  v_mfma_f32_32x32x16_bf16 v[96:111], v[60:63], v[128:131], v[96:111]
  ds_read_b64_tr_b16 v[48:49], v12 offset:13312
  ds_read_b64_tr_b16 v[50:51], v12 offset:13568
  buffer_load_dwordx4 v245, s[52:55], s31 offen offset:1024 lds
  s_waitcnt lgkmcnt(4)
  ds_read_b32 v173, v1 offset:52
  v_mfma_f32_32x32x16_bf16 v[80:95], v[68:71], v[132:135], v[80:95]
  ds_read_b64_tr_b16 v[56:57], v13 offset:12288
  ds_read_b64_tr_b16 v[58:59], v13 offset:12544
  v_mfma_f32_16x16x32_bf16 v[188:191], v[232:235], v[72:75], v[188:191]
  s_add_u32 m0, s87, 4096
  s_nop 0
  buffer_load_dwordx4 v240, s[48:51], s23 offen offset:0 lds
  v_mfma_f32_32x32x16_bf16 v[96:111], v[72:75], v[132:135], v[96:111]
  ds_read_b64_tr_b16 v[60:61], v13 offset:13312
  ds_read_b64_tr_b16 v[62:63], v13 offset:13568
  buffer_load_dwordx4 v241, s[48:51], s23 offen offset:1024 lds
  s_waitcnt lgkmcnt(4)
  v_readfirstlane_b32 s15, v173
  s_nop 0
  s_cmp_ge_u32 s15, 4
  s_cbranch_scc1 L_lwd_50
L_lw_49:
  s_sleep 1
  ds_read_b32 v173, v1 offset:52
  s_sub_u32 s76, s76, 1
  s_waitcnt lgkmcnt(0)
  v_readfirstlane_b32 s15, v173
  s_cmp_lt_i32 s76, 0
  s_cselect_b32 s15, 4, s15
  s_cmp_ge_u32 s15, 4
  s_cbranch_scc0 L_lw_49
L_lwd_50:
  v_mfma_f32_32x32x16_bf16 v[80:95], v[44:47], v[136:139], v[80:95]
  ds_read_b64_tr_b16 v[68:69], v10 offset:24576
  ds_read_b64_tr_b16 v[70:71], v10 offset:24832
  buffer_load_dwordx4 v242, s[48:51], s23 offen offset:2048 lds
  v_mfma_f32_32x32x16_bf16 v[96:111], v[48:51], v[136:139], v[96:111]
  ds_read_b64_tr_b16 v[72:73], v10 offset:25600
  ds_read_b64_tr_b16 v[74:75], v10 offset:25856
  buffer_load_dwordx4 v243, s[48:51], s23 offen offset:3072 lds
  s_waitcnt lgkmcnt(4)
  v_mfma_f32_32x32x16_bf16 v[80:95], v[56:59], v[140:143], v[80:95]
  ds_read_b64_tr_b16 v[44:45], v11 offset:24576
  ds_read_b64_tr_b16 v[46:47], v11 offset:24832
  buffer_load_dword v5, v1, s[72:75], 0 offen sc1
  v_mfma_f32_32x32x16_bf16 v[96:111], v[60:63], v[140:143], v[96:111]
  ds_read_b64_tr_b16 v[48:49], v11 offset:25600
  ds_read_b64_tr_b16 v[50:51], v11 offset:25856
  buffer_load_dwordx4 v[168:171], v228, s[44:47], s93 offen sc1
  s_waitcnt vmcnt(8)
  s_mov_b64 exec, 1
  ds_add_u32 v1, v2 offset:56
  s_mov_b64 exec, -1
  ds_read_b128 v[128:131], v224 offset:0
  ds_read_b128 v[132:135], v225 offset:0
  ds_read_b128 v[136:139], v226 offset:0
  ds_read_b128 v[140:143], v227 offset:0
  s_waitcnt lgkmcnt(9)
  v_mfma_f32_32x32x16_bf16 v[80:95], v[68:71], v[144:147], v[80:95]
  ds_read_b64_tr_b16 v[56:57], v12 offset:24576
  ds_read_b64_tr_b16 v[58:59], v12 offset:24832
  v_mfma_f32_16x16x32_bf16 v[184:187], v[232:235], v[68:71], v[184:187]
  v_mfma_f32_32x32x16_bf16 v[96:111], v[72:75], v[144:147], v[96:111]
  ds_read_b64_tr_b16 v[60:61], v12 offset:25600
  ds_read_b64_tr_b16 v[62:63], v12 offset:25856
  s_waitcnt lgkmcnt(4)
  ds_read_b32 v173, v1 offset:56
  v_mfma_f32_32x32x16_bf16 v[80:95], v[44:47], v[148:151], v[80:95]
  ds_read_b64_tr_b16 v[68:69], v13 offset:24576
  ds_read_b64_tr_b16 v[70:71], v13 offset:24832
  v_mfma_f32_16x16x32_bf16 v[188:191], v[232:235], v[48:51], v[188:191]
  v_mfma_f32_32x32x16_bf16 v[96:111], v[48:51], v[148:151], v[96:111]
  ds_read_b64_tr_b16 v[72:73], v13 offset:25600
  ds_read_b64_tr_b16 v[74:75], v13 offset:25856
  s_waitcnt lgkmcnt(4)
  v_readfirstlane_b32 s15, v173
  s_nop 0
  s_cmp_ge_u32 s15, 4
  s_cbranch_scc1 L_lwd_52
L_lw_51:
  s_sleep 1
  ds_read_b32 v173, v1 offset:56
  s_sub_u32 s76, s76, 1
  s_waitcnt lgkmcnt(0)
  v_readfirstlane_b32 s15, v173
  s_cmp_lt_i32 s76, 0
  s_cselect_b32 s15, 4, s15
  s_cmp_ge_u32 s15, 4
  s_cbranch_scc0 L_lw_51
L_lwd_52:
  v_mfma_f32_32x32x16_bf16 v[80:95], v[56:59], v[152:155], v[80:95]
  ds_read_b64_tr_b16 v[44:45], v10 offset:36864
  ds_read_b64_tr_b16 v[46:47], v10 offset:37120
  v_mfma_f32_32x32x16_bf16 v[96:111], v[60:63], v[152:155], v[96:111]
  ds_read_b64_tr_b16 v[48:49], v10 offset:37888
  ds_read_b64_tr_b16 v[50:51], v10 offset:38144
  s_waitcnt lgkmcnt(4)
  v_mfma_f32_32x32x16_bf16 v[80:95], v[68:71], v[156:159], v[80:95]
  ds_read_b64_tr_b16 v[56:57], v11 offset:36864
  ds_read_b64_tr_b16 v[58:59], v11 offset:37120
  v_mfma_f32_32x32x16_bf16 v[96:111], v[72:75], v[156:159], v[96:111]
  ds_read_b64_tr_b16 v[60:61], v11 offset:37888
  ds_read_b64_tr_b16 v[62:63], v11 offset:38144
  s_waitcnt vmcnt(2)
  s_mov_b64 exec, 1
  ds_add_u32 v1, v2 offset:60
  s_mov_b64 exec, -1
  ds_read_b128 v[144:147], v224 offset:4096
  ds_read_b128 v[148:151], v225 offset:4096
  ds_read_b128 v[152:155], v226 offset:4096
  ds_read_b128 v[156:159], v227 offset:4096
  s_waitcnt lgkmcnt(9)
  v_mfma_f32_32x32x16_bf16 v[80:95], v[44:47], v[128:131], v[80:95]
  ds_read_b64_tr_b16 v[68:69], v12 offset:36864
  ds_read_b64_tr_b16 v[70:71], v12 offset:37120
  v_mfma_f32_16x16x32_bf16 v[184:187], v[232:235], v[44:47], v[184:187]
  v_mfma_f32_32x32x16_bf16 v[96:111], v[48:51], v[128:131], v[96:111]
  ds_read_b64_tr_b16 v[72:73], v12 offset:37888
  ds_read_b64_tr_b16 v[74:75], v12 offset:38144
  s_waitcnt lgkmcnt(4)
  ds_read_b32 v173, v1 offset:60
  s_waitcnt vmcnt(0)
  v_readfirstlane_b32 s14, v5
  s_nop 0
  s_cmp_lg_u32 s14, 0
  s_cbranch_scc1 L_nwd_54
L_nw_53:
  buffer_load_dword v5, v1, s[72:75], 0 offen sc1
  s_sub_u32 s76, s76, 1
  s_waitcnt vmcnt(0)
  v_readfirstlane_b32 s14, v5
  s_cmp_lt_i32 s76, 0
  s_cselect_b32 s14, 1, s14
  s_cmp_lg_u32 s14, 0
  s_cbranch_scc0 L_nw_53
L_nwd_54:
  s_waitcnt vmcnt(0)
  v_cmp_ne_u32 s[98:99], s14, v168
  v_cmp_ne_u32 vcc, s14, v170
  s_nop 0
  s_or_b64 vcc, vcc, s[98:99]
  s_cbranch_vccz L_pd_56
  s_mov_b64 exec, vcc
L_p_55:
  s_sleep 4
  buffer_load_dwordx4 v[168:171], v228, s[44:47], s93 offen sc1
  s_sub_u32 s76, s76, 1
  s_waitcnt vmcnt(0)
  v_cmp_ne_u32 s[98:99], s14, v168
  v_cmp_ne_u32 vcc, s14, v170
  s_nop 0
  s_or_b64 vcc, vcc, s[98:99]
  s_cmp_gt_i32 s76, 0
  s_cselect_b64 exec, vcc, 0
  s_cbranch_execnz L_p_55
L_pd_56:
  s_mov_b64 exec, -1
  v_and_b32 v3, 1, v0
  v_lshlrev_b32 v3, 4, v3
  v_lshrrev_b32 v3, v3, v169
  v_and_b32 v3, 0xffff, v3
  v_lshl_or_b32 v180, v3, 16, v3
  v_lshl_or_b32 v181, v3, 16, v3
  v_lshl_or_b32 v182, v3, 16, v3
  v_lshl_or_b32 v183, v3, 16, v3
  v_mfma_f32_32x32x16_bf16 v[80:95], v[56:59], v[132:135], v[80:95]
  ds_read_b64_tr_b16 v[44:45], v13 offset:36864
  ds_read_b64_tr_b16 v[46:47], v13 offset:37120
  v_mfma_f32_16x16x32_bf16 v[188:191], v[232:235], v[60:63], v[188:191]
  v_mfma_f32_32x32x16_bf16 v[96:111], v[60:63], v[132:135], v[96:111]
  ds_read_b64_tr_b16 v[48:49], v13 offset:37888
  ds_read_b64_tr_b16 v[50:51], v13 offset:38144
  s_waitcnt lgkmcnt(4)
  v_readfirstlane_b32 s15, v173
  s_nop 0
  s_cmp_ge_u32 s15, 4
  s_cbranch_scc1 L_lwd_58
L_lw_57:
  s_sleep 1
  ds_read_b32 v173, v1 offset:60
  s_sub_u32 s76, s76, 1
  s_waitcnt lgkmcnt(0)
  v_readfirstlane_b32 s15, v173
  s_cmp_lt_i32 s76, 0
  s_cselect_b32 s15, 4, s15
  s_cmp_ge_u32 s15, 4
  s_cbranch_scc0 L_lw_57
L_lwd_58:
  v_mfma_f32_32x32x16_bf16 v[80:95], v[68:71], v[136:139], v[80:95]
  ds_read_b64_tr_b16 v[56:57], v10 offset:49152
  ds_read_b64_tr_b16 v[58:59], v10 offset:49408
  v_mfma_f32_32x32x16_bf16 v[96:111], v[72:75], v[136:139], v[96:111]
  ds_read_b64_tr_b16 v[60:61], v10 offset:50176
  ds_read_b64_tr_b16 v[62:63], v10 offset:50432
  s_waitcnt lgkmcnt(4)
  v_mfma_f32_32x32x16_bf16 v[80:95], v[44:47], v[140:143], v[80:95]
  ds_read_b64_tr_b16 v[68:69], v11 offset:49152
  ds_read_b64_tr_b16 v[70:71], v11 offset:49408
  v_mfma_f32_32x32x16_bf16 v[96:111], v[48:51], v[140:143], v[96:111]
  ds_read_b64_tr_b16 v[72:73], v11 offset:50176
  ds_read_b64_tr_b16 v[74:75], v11 offset:50432
  s_waitcnt lgkmcnt(4)
  v_mfma_f32_32x32x16_bf16 v[80:95], v[56:59], v[144:147], v[80:95]
  ds_read_b64_tr_b16 v[44:45], v12 offset:49152
  ds_read_b64_tr_b16 v[46:47], v12 offset:49408
  v_mfma_f32_16x16x32_bf16 v[184:187], v[232:235], v[56:59], v[184:187]
  v_mfma_f32_32x32x16_bf16 v[96:111], v[60:63], v[144:147], v[96:111]
  ds_read_b64_tr_b16 v[48:49], v12 offset:50176
  ds_read_b64_tr_b16 v[50:51], v12 offset:50432
  v_mfma_f32_16x16x32_bf16 v[188:191], v[232:235], v[60:63], v[188:191]
  s_waitcnt lgkmcnt(4)
  v_mfma_f32_32x32x16_bf16 v[80:95], v[68:71], v[148:151], v[80:95]
  ds_read_b64_tr_b16 v[56:57], v13 offset:49152
  ds_read_b64_tr_b16 v[58:59], v13 offset:49408
  v_cvt_pk_bf16_f32 v3, v184, v185
  v_lshlrev_b32_e64 v236, 16, v3
  v_and_b32 v3, 0xffff0000, v3
  v_sub_f32 v236, v184, v236
  v_sub_f32 v3, v185, v3
  v_cvt_pk_bf16_f32 v184, v184, v236
  v_cvt_pk_bf16_f32 v185, v185, v3
  v_mfma_f32_32x32x16_bf16 v[96:111], v[72:75], v[148:151], v[96:111]
  ds_read_b64_tr_b16 v[60:61], v13 offset:50176
  ds_read_b64_tr_b16 v[62:63], v13 offset:50432
  v_cvt_pk_bf16_f32 v3, v188, v189
  v_lshlrev_b32_e64 v236, 16, v3
  v_and_b32 v3, 0xffff0000, v3
  v_sub_f32 v236, v188, v236
  v_sub_f32 v3, v189, v3
  v_cvt_pk_bf16_f32 v188, v188, v236
  v_cvt_pk_bf16_f32 v189, v189, v3
  s_mov_b64 exec, 0xffff
  ds_write2st64_b32 v14, v184, v185 offset0:0 offset1:2
  ds_write2st64_b32 v14, v188, v189 offset0:4 offset1:6
  s_mov_b64 exec, 1
  ds_add_u32 v1, v2 offset:28
  s_mov_b64 exec, -1
  s_waitcnt lgkmcnt(7)
  v_mfma_f32_32x32x16_bf16 v[80:95], v[44:47], v[152:155], v[80:95]
  v_mfma_f32_32x32x16_bf16 v[96:111], v[48:51], v[152:155], v[96:111]
  ds_read_b32 v173, v1 offset:28
  s_waitcnt lgkmcnt(1)
  s_mov_b64 exec, 1
  ds_add_u32 v1, v2 offset:24
  s_mov_b64 exec, -1
  s_waitcnt lgkmcnt(1)
  v_readfirstlane_b32 s15, v173
  s_nop 0
  s_cmp_ge_u32 s15, 4
  s_cbranch_scc1 L_lwd_60
L_lw_59:
  s_sleep 1
  ds_read_b32 v173, v1 offset:28
  s_sub_u32 s76, s76, 1
  s_waitcnt lgkmcnt(0)
  v_readfirstlane_b32 s15, v173
  s_cmp_lt_i32 s76, 0
  s_cselect_b32 s15, 4, s15
  s_cmp_ge_u32 s15, 4
  s_cbranch_scc0 L_lw_59
L_lwd_60:
  ds_read_b128 v[68:71], v229 offset:0
  ds_read_b128 v[72:75], v229 offset:1024
  v_mfma_f32_32x32x16_bf16 v[80:95], v[56:59], v[156:159], v[80:95]
  v_mfma_f32_32x32x16_bf16 v[96:111], v[60:63], v[156:159], v[96:111]
  s_waitcnt lgkmcnt(1)
  v_mfma_f32_32x32x16_bf16 v[80:95], v[68:71], v[180:183], v[80:95]
  s_waitcnt lgkmcnt(0)
  v_mfma_f32_32x32x16_bf16 v[96:111], v[72:75], v[180:183], v[96:111]
  s_nop 9
  v_cvt_pk_bf16_f32 v16, v80, v81
  v_cvt_pk_bf16_f32 v17, v82, v83
  v_cvt_pk_bf16_f32 v18, v84, v85
  v_cvt_pk_bf16_f32 v19, v86, v87
  v_pk_max_i16 v16, v16, 0
  v_pk_max_i16 v17, v17, 0
  v_pk_max_i16 v18, v18, 0
  v_pk_max_i16 v19, v19, 0
  buffer_store_dwordx4 v[16:19], v4, s[44:47], s64 offen offset:0 sc1
  v_cvt_pk_bf16_f32 v20, v88, v89
  v_cvt_pk_bf16_f32 v21, v90, v91
  v_cvt_pk_bf16_f32 v22, v92, v93
  v_cvt_pk_bf16_f32 v23, v94, v95
  v_pk_max_i16 v20, v20, 0
  v_pk_max_i16 v21, v21, 0
  v_pk_max_i16 v22, v22, 0
  v_pk_max_i16 v23, v23, 0
  buffer_store_dwordx4 v[20:23], v4, s[44:47], s64 offen offset:1024 sc1
  v_cvt_pk_bf16_f32 v24, v96, v97
  v_cvt_pk_bf16_f32 v25, v98, v99
  v_cvt_pk_bf16_f32 v26, v100, v101
  v_cvt_pk_bf16_f32 v27, v102, v103
  v_pk_max_i16 v24, v24, 0
  v_pk_max_i16 v25, v25, 0
  v_pk_max_i16 v26, v26, 0
  v_pk_max_i16 v27, v27, 0
  buffer_store_dwordx4 v[24:27], v4, s[44:47], s64 offen offset:2048 sc1
  v_cvt_pk_bf16_f32 v28, v104, v105
  v_cvt_pk_bf16_f32 v29, v106, v107
  v_cvt_pk_bf16_f32 v30, v108, v109
  v_cvt_pk_bf16_f32 v31, v110, v111
  v_pk_max_i16 v28, v28, 0
  v_pk_max_i16 v29, v29, 0
  v_pk_max_i16 v30, v30, 0
  v_pk_max_i16 v31, v31, 0
  buffer_store_dwordx4 v[28:31], v4, s[44:47], s64 offen offset:3072 sc1
  s_mov_b64 exec, 1
  ds_add_u32 v1, v2 offset:92
  s_mov_b64 exec, -1
  s_branch L_G1done
L_G3t:
  s_barrier
  s_add_u32 s77, s84, 0
  s_and_b32 s77, s77, 7
  s_lshl_b32 s77, s77, 7
  s_add_u32 m0, s87, 0
  s_add_u32 s77, s77, s85
  buffer_load_dwordx4 v240, s[48:51], s77 offen offset:0 lds
  buffer_load_dwordx4 v241, s[48:51], s77 offen offset:1024 lds
  buffer_load_dwordx4 v242, s[48:51], s77 offen offset:2048 lds
  buffer_load_dwordx4 v243, s[48:51], s77 offen offset:3072 lds
  s_add_u32 s79, s84, 0
  s_and_b32 s79, s79, 7
  s_mul_i32 s79, s79, 176128
  s_add_u32 m0, s78, 24576
  s_add_u32 s79, s79, s86
  buffer_load_dwordx4 v244, s[52:55], s79 offen offset:0 lds
  buffer_load_dwordx4 v245, s[52:55], s79 offen offset:1024 lds
  buffer_load_dwordx4 v246, s[52:55], s79 offen offset:2048 lds
  s_add_u32 s79, s84, 1
  s_and_b32 s79, s79, 7
  s_mul_i32 s79, s79, 176128
  s_add_u32 m0, s78, 36864
  s_add_u32 s79, s79, s86
  buffer_load_dwordx4 v244, s[52:55], s79 offen offset:0 lds
  buffer_load_dwordx4 v245, s[52:55], s79 offen offset:1024 lds
  buffer_load_dwordx4 v246, s[52:55], s79 offen offset:2048 lds
  s_add_u32 s15, s84, 2
  s_and_b32 s15, s15, 7
  s_lshl_b32 s18, s15, 7
  s_add_u32 s18, s18, s85
  s_mul_i32 s26, s15, 176128
  s_add_u32 s26, s26, s86
  s_add_u32 s15, s84, 3
  s_and_b32 s15, s15, 7
  s_lshl_b32 s19, s15, 7
  s_add_u32 s19, s19, s85
  s_mul_i32 s27, s15, 176128
  s_add_u32 s27, s27, s86
  s_add_u32 s15, s84, 4
  s_and_b32 s15, s15, 7
  s_lshl_b32 s20, s15, 7
  s_add_u32 s20, s20, s85
  s_mul_i32 s28, s15, 176128
  s_add_u32 s28, s28, s86
  s_add_u32 s15, s84, 5
  s_and_b32 s15, s15, 7
  s_lshl_b32 s21, s15, 7
  s_add_u32 s21, s21, s85
  s_mul_i32 s29, s15, 176128
  s_add_u32 s29, s29, s86
  s_add_u32 s15, s84, 6
  s_and_b32 s15, s15, 7
  s_lshl_b32 s22, s15, 7
  s_add_u32 s22, s22, s85
  s_mul_i32 s30, s15, 176128
  s_add_u32 s30, s30, s86
  s_add_u32 s15, s84, 7
  s_and_b32 s15, s15, 7
  s_lshl_b32 s23, s15, 7
  s_add_u32 s23, s23, s85
  s_mul_i32 s31, s15, 176128
  s_add_u32 s31, s31, s86
  v_and_b32 v3, 3, v0
  v_lshrrev_b32 v10, 5, v0
  v_lshlrev_b32 v10, 9, v10
  v_bfe_u32 v11, v0, 2, 2
  v_lshl_add_u32 v10, v11, 6, v10
  v_bfe_u32 v11, v0, 4, 1
  v_lshl_add_u32 v10, v11, 5, v10
  v_lshl_add_u32 v10, v3, 3, v10
  s_xor_b32 s15, s42, 3
  s_mul_i32 s15, s15, 3072
  s_add_u32 s15, s15, 87552
  v_add_u32_e64 v13, s15, v10
  s_xor_b32 s15, s42, 2
  s_mul_i32 s15, s15, 3072
  s_add_u32 s15, s15, 87552
  v_add_u32 v12, s15, v10
  s_xor_b32 s15, s42, 1
  s_mul_i32 s15, s15, 3072
  s_add_u32 s15, s15, 87552
  v_add_u32 v11, s15, v10
  s_xor_b32 s15, s42, 0
  s_mul_i32 s15, s15, 3072
  s_add_u32 s15, s15, 87552
  v_add_u32_e64 v10, s15, v10
  v_bfe_u32 v3, v0, 1, 3
  v_lshrrev_b32 v224, 5, v0
  v_xor_b32 v3, v3, v224
  v_lshlrev_b32 v3, 4, v3
  v_and_b32 v224, 31, v0
  v_lshl_add_u32 v3, v224, 7, v3
  v_add_u32 v3, s87, v3
  s_xor_b32 s15, s42, 0
  s_lshl_b32 s15, s15, 5
  v_xor_b32 v224, s15, v3
  s_xor_b32 s15, s42, 1
  s_lshl_b32 s15, s15, 5
  v_xor_b32 v225, s15, v3
  s_xor_b32 s15, s42, 2
  s_lshl_b32 s15, s15, 5
  v_xor_b32 v226, s15, v3
  s_xor_b32 s15, s42, 3
  s_lshl_b32 s15, s15, 5
  v_xor_b32 v227, s15, v3
  v_and_b32 v3, 15, v0
  v_bfe_u32 v232, v0, 4, 1
  v_cmp_eq_u32 vcc, v3, v232
  v_mov_b32 v3, 0x3f803f80
  s_nop 0
  v_cndmask_b32 v232, 0, v3, vcc
  v_cndmask_b32 v233, 0, v3, vcc
  v_cndmask_b32 v234, 0, v3, vcc
  v_cndmask_b32 v235, 0, v3, vcc
  v_lshlrev_b32_e64 v4, 4, v0
  v_bfe_u32 v3, v0, 1, 2
  v_lshlrev_b32_e64 v228, 4, v3
  v_bfe_u32 v3, v0, 3, 2
  v_lshl_add_u32 v228, v3, 7, v228
  s_lshr_b32 s93, s85, 6
  s_add_u32 s93, s93, 12976128
  v_lshrrev_b32 v8, 3, v0
  v_lshlrev_b32_e64 v8, 10, v8
  v_bfe_u32 v3, v0, 4, 1
  v_lshlrev_b32 v3, 2, v3
  v_and_b32 v14, 7, v0
  v_xor_b32_e64 v3, v3, v14
  v_lshl_add_u32 v8, v3, 4, v8
  v_add_u32 v9, 7168, v8
  s_mul_i32 s15, s10, 0
  s_mul_i32 s91, s11, 0
  s_add_u32 s15, s15, s91
  s_and_b32 s15, s15, 7
  s_mul_i32 s15, s15, 11
  s_lshr_b32 s15, s15, 2
  s_sub_u32 s89, 22, s15
  s_mul_i32 s91, s42, 22
  s_add_u32 s91, s91, s15
  s_lshl_b32 s88, s91, 14
  s_lshl_b32 s91, s91, 10
  s_lshl_b32 s15, s11, 7
  s_add_u32 s88, s88, s15
  s_sub_u32 s94, s88, 360448
  s_sub_u32 s95, s91, 22528
  s_lshl_b32 s90, s42, 11
  s_add_u32 s90, s90, 50688
  v_and_b32 v14, 31, v0
  v_lshlrev_b32 v14, 5, v14
  v_lshrrev_b32 v3, 5, v0
  v_lshl_add_u32 v229, v3, 4, v14
  s_lshl_b32 s15, s42, 3
  s_add_u32 s15, s15, 157184
  v_add_u32_e64 v14, s15, v14
  v_add_u32 v229, 157184, v229
  v_lshrrev_b32 v238, 5, v0
  v_lshlrev_b32 v238, 9, v238
  v_bfe_u32 v3, v0, 2, 2
  v_lshl_add_u32 v238, v3, 7, v238
  v_bfe_u32 v3, v0, 3, 1
  v_lshl_add_u32 v238, v3, 6, v238
  v_and_b32_e64 v3, 1, v0
  v_lshl_add_u32 v238, v3, 5, v238
  v_bfe_u32 v3, v0, 4, 1
  v_lshl_add_u32 v238, v3, 4, v238
  v_bfe_u32 v3, v0, 1, 1
  v_lshl_add_u32 v238, v3, 3, v238
  v_xor_b32 v239, 64, v238
  v_add_u32 v238, s90, v238
  v_add_u32_e64 v239, s90, v239
  s_lshr_b32 s64, s85, 15
  s_lshr_b32 s66, s64, 1
  s_lshl_b32 s66, s66, 9
  s_and_b32 s15, s64, 1
  s_lshl_b32 s15, s15, 2
  s_add_u32 s66, s66, s15
  s_mul_i32 s64, s64, 88064
  s_lshl_b32 s15, s12, 11
  s_add_u32 s64, s64, s15
  s_add_u32 s64, s64, 4194304
  s_add_u32 s65, s64, 4096
  s_add_u32 s66, s66, 12713984
  s_and_b32 s15, s7, 3
  s_lshl_b32 s15, s15, 3
  s_lshr_b32 s98, s7, 2
  s_lshl_b32 s98, s98, 7
  s_add_u32 s67, s98, 128
  s_add_u32 s67, s67, s66
  s_add_u32 s98, s98, s15
  s_bfe_u32 s15, s7, 0x10002
  s_lshl_b32 s15, s15, 3
  s_add_u32 s98, s98, s15
  s_add_u32 s66, s66, s98
  ds_write_b32 v14, v1 offset:4
  ds_write_b32 v14, v1 offset:1028
  ds_write_b32 v14, v1 offset:2052
  s_lshl_b32 s96, s42, 13
  s_add_u32 s96, s96, 50688
  v_lshlrev_b32 v25, 7, v0
  v_and_b32 v26, 7, v0
  v_lshl_add_u32 v25, v26, 4, v25
  v_xor_b32 v200, 0, v25
  v_add_u32 v200, s96, v200
  v_xor_b32 v201, 16, v25
  v_add_u32 v201, s96, v201
  v_xor_b32 v202, 32, v25
  v_add_u32 v202, s96, v202
  v_xor_b32 v203, 48, v25
  v_add_u32 v203, s96, v203
  v_xor_b32 v204, 64, v25
  v_add_u32 v204, s96, v204
  v_xor_b32 v205, 80, v25
  v_add_u32_e64 v205, s96, v205
  v_xor_b32 v206, 96, v25
  v_add_u32_e64 v206, s96, v206
  v_xor_b32 v207, 112, v25
  v_add_u32 v207, s96, v207
  s_lshl_b32 s15, s42, 2
  v_mov_b32 v210, s15
  s_waitcnt vmcnt(10)
  s_mov_b32 s60, 0x3fb8aa3b
  s_lshr_b32 s15, s42, 1
  s_lshl_b32 s15, s15, 4
  v_lshrrev_b32 v24, s15, v24
  v_lshlrev_b32 v24, 16, v24
  v_lshlrev_b32 v20, 16, v20
  v_lshlrev_b32 v21, 16, v21
  v_mul_f32 v29, 0x3fb8aa3b, v24
  v_fma_f32 v30, v24, s60, -v29
  v_fmac_f32 v30, 0x32a5705f, v24
  v_exp_f32_e64 v28, v29
  v_mul_f32 v30, 0x3f317218, v30
  v_fmac_f32_e64 v28, v28, v30
  v_cvt_pk_bf16_f32 v28, v28, v28
  v_lshlrev_b32_e64 v28, 16, v28
  v_mul_f32 v29, 0x3fb8aa3b, v20
  v_fma_f32 v30, v20, s60, -v29
  v_fmac_f32 v30, 0x32a5705f, v20
  v_exp_f32_e64 v31, v29
  v_mul_f32 v30, 0x3f317218, v30
  v_fmac_f32_e64 v31, v31, v30
  v_cvt_pk_bf16_f32 v31, v31, v31
  v_lshlrev_b32 v31, 16, v31
  v_mul_f32 v20, v31, v28
  v_mul_f32_e64 v21, v21, v28
  v_mul_f32 v20, 0xbfb8aa3b, v20
  v_mul_f32_e64 v21, 0x3e22f983, v21
  v_mul_f32 v60, 0x41000000, v20
  v_mul_f32 v61, 0x41000000, v21
  v_exp_f32 v60, v60
  v_fract_f32 v61, v61
  v_cos_f32 v34, v61
  v_sin_f32 v35, v61
  v_mul_f32 v62, 0x42000000, v20
  v_mul_f32 v63, 0x42000000, v21
  v_exp_f32 v62, v62
  v_fract_f32 v63, v63
  v_cos_f32 v50, v63
  v_sin_f32 v51, v63
  v_mul_f32 v56, 0x41800000, v20
  v_mul_f32 v57, 0x41800000, v21
  v_exp_f32 v56, v56
  v_fract_f32 v57, v57
  v_cos_f32 v36, v57
  v_sin_f32 v37, v57
  v_pk_mul_f32 v[34:35], v[34:35], v[60:61] op_sel_hi:[1,0]
  v_pk_mul_f32 v[50:51], v[50:51], v[62:63] op_sel_hi:[1,0]
  v_pk_mul_f32 v[36:37], v[36:37], v[56:57] op_sel_hi:[1,0]
  v_mov_b32 v32, 1.0
  v_mov_b32 v33, 0
  v_mov_b32 v48, v35
  v_mov_b32 v52, v51
  v_pk_mul_f32 v[38:39], v[36:37], v[34:35] op_sel_hi:[1,0]
  v_pk_fma_f32 v[38:39], v[36:37], v[48:49], v[38:39] op_sel:[1,0,0] op_sel_hi:[0,0,1] neg_lo:[1,0,0]
  v_pk_mul_f32 v[40:41], v[32:33], v[50:51] op_sel_hi:[1,0]
  v_pk_mul_f32 v[42:43], v[34:35], v[50:51] op_sel_hi:[1,0]
  v_pk_mul_f32 v[44:45], v[36:37], v[50:51] op_sel_hi:[1,0]
  v_pk_mul_f32 v[46:47], v[38:39], v[50:51] op_sel_hi:[1,0]
  v_pk_fma_f32 v[40:41], v[32:33], v[52:53], v[40:41] op_sel:[1,0,0] op_sel_hi:[0,0,1] neg_lo:[1,0,0]
  v_pk_fma_f32 v[42:43], v[34:35], v[52:53], v[42:43] op_sel:[1,0,0] op_sel_hi:[0,0,1] neg_lo:[1,0,0]
  v_pk_fma_f32 v[44:45], v[36:37], v[52:53], v[44:45] op_sel:[1,0,0] op_sel_hi:[0,0,1] neg_lo:[1,0,0]
  v_pk_fma_f32 v[46:47], v[38:39], v[52:53], v[46:47] op_sel:[1,0,0] op_sel_hi:[0,0,1] neg_lo:[1,0,0]
  v_cvt_pk_bf16_f32 v136, v32, v34
  v_cvt_pk_bf16_f32 v152, v33, v35
  v_cvt_pk_bf16_f32 v137, v36, v38
  v_cvt_pk_bf16_f32 v153, v37, v39
  v_pk_mul_f32 v[32:33], v[40:41], v[50:51] op_sel_hi:[1,0]
  v_pk_mul_f32 v[34:35], v[42:43], v[50:51] op_sel_hi:[1,0]
  v_pk_mul_f32 v[36:37], v[44:45], v[50:51] op_sel_hi:[1,0]
  v_pk_mul_f32 v[38:39], v[46:47], v[50:51] op_sel_hi:[1,0]
  v_pk_fma_f32 v[32:33], v[40:41], v[52:53], v[32:33] op_sel:[1,0,0] op_sel_hi:[0,0,1] neg_lo:[1,0,0]
  v_pk_fma_f32 v[34:35], v[42:43], v[52:53], v[34:35] op_sel:[1,0,0] op_sel_hi:[0,0,1] neg_lo:[1,0,0]
  v_pk_fma_f32 v[36:37], v[44:45], v[52:53], v[36:37] op_sel:[1,0,0] op_sel_hi:[0,0,1] neg_lo:[1,0,0]
  v_pk_fma_f32 v[38:39], v[46:47], v[52:53], v[38:39] op_sel:[1,0,0] op_sel_hi:[0,0,1] neg_lo:[1,0,0]
  v_cvt_pk_bf16_f32 v138, v40, v42
  v_cvt_pk_bf16_f32 v154, v41, v43
  v_cvt_pk_bf16_f32 v139, v44, v46
  v_cvt_pk_bf16_f32 v155, v45, v47
  v_pk_mul_f32 v[40:41], v[32:33], v[50:51] op_sel_hi:[1,0]
  v_pk_mul_f32 v[42:43], v[34:35], v[50:51] op_sel_hi:[1,0]
  v_pk_mul_f32 v[44:45], v[36:37], v[50:51] op_sel_hi:[1,0]
  v_pk_mul_f32 v[46:47], v[38:39], v[50:51] op_sel_hi:[1,0]
  v_pk_fma_f32 v[40:41], v[32:33], v[52:53], v[40:41] op_sel:[1,0,0] op_sel_hi:[0,0,1] neg_lo:[1,0,0]
  v_pk_fma_f32 v[42:43], v[34:35], v[52:53], v[42:43] op_sel:[1,0,0] op_sel_hi:[0,0,1] neg_lo:[1,0,0]
  v_pk_fma_f32 v[44:45], v[36:37], v[52:53], v[44:45] op_sel:[1,0,0] op_sel_hi:[0,0,1] neg_lo:[1,0,0]
  v_pk_fma_f32 v[46:47], v[38:39], v[52:53], v[46:47] op_sel:[1,0,0] op_sel_hi:[0,0,1] neg_lo:[1,0,0]
  v_cvt_pk_bf16_f32 v140, v32, v34
  v_cvt_pk_bf16_f32 v156, v33, v35
  v_cvt_pk_bf16_f32 v141, v36, v38
  v_cvt_pk_bf16_f32 v157, v37, v39
  v_pk_mul_f32 v[32:33], v[40:41], v[50:51] op_sel_hi:[1,0]
  v_pk_mul_f32 v[34:35], v[42:43], v[50:51] op_sel_hi:[1,0]
  v_pk_mul_f32 v[36:37], v[44:45], v[50:51] op_sel_hi:[1,0]
  v_pk_mul_f32 v[38:39], v[46:47], v[50:51] op_sel_hi:[1,0]
  v_pk_fma_f32 v[32:33], v[40:41], v[52:53], v[32:33] op_sel:[1,0,0] op_sel_hi:[0,0,1] neg_lo:[1,0,0]
  v_pk_fma_f32 v[34:35], v[42:43], v[52:53], v[34:35] op_sel:[1,0,0] op_sel_hi:[0,0,1] neg_lo:[1,0,0]
  v_pk_fma_f32 v[36:37], v[44:45], v[52:53], v[36:37] op_sel:[1,0,0] op_sel_hi:[0,0,1] neg_lo:[1,0,0]
  v_pk_fma_f32 v[38:39], v[46:47], v[52:53], v[38:39] op_sel:[1,0,0] op_sel_hi:[0,0,1] neg_lo:[1,0,0]
  v_cvt_pk_bf16_f32 v142, v40, v42
  v_cvt_pk_bf16_f32 v158, v41, v43
  v_cvt_pk_bf16_f32 v143, v44, v46
  v_cvt_pk_bf16_f32 v159, v45, v47
  v_pk_mul_f32 v[40:41], v[32:33], v[50:51] op_sel_hi:[1,0]
  v_pk_mul_f32 v[42:43], v[34:35], v[50:51] op_sel_hi:[1,0]
  v_pk_mul_f32 v[44:45], v[36:37], v[50:51] op_sel_hi:[1,0]
  v_pk_mul_f32 v[46:47], v[38:39], v[50:51] op_sel_hi:[1,0]
  v_pk_fma_f32 v[40:41], v[32:33], v[52:53], v[40:41] op_sel:[1,0,0] op_sel_hi:[0,0,1] neg_lo:[1,0,0]
  v_pk_fma_f32 v[42:43], v[34:35], v[52:53], v[42:43] op_sel:[1,0,0] op_sel_hi:[0,0,1] neg_lo:[1,0,0]
  v_pk_fma_f32 v[44:45], v[36:37], v[52:53], v[44:45] op_sel:[1,0,0] op_sel_hi:[0,0,1] neg_lo:[1,0,0]
  v_pk_fma_f32 v[46:47], v[38:39], v[52:53], v[46:47] op_sel:[1,0,0] op_sel_hi:[0,0,1] neg_lo:[1,0,0]
  v_cvt_pk_bf16_f32 v144, v32, v34
  v_cvt_pk_bf16_f32 v160, v33, v35
  v_cvt_pk_bf16_f32 v145, v36, v38
  v_cvt_pk_bf16_f32 v161, v37, v39
  v_pk_mul_f32 v[32:33], v[40:41], v[50:51] op_sel_hi:[1,0]
  v_pk_mul_f32 v[34:35], v[42:43], v[50:51] op_sel_hi:[1,0]
  v_pk_mul_f32 v[36:37], v[44:45], v[50:51] op_sel_hi:[1,0]
  v_pk_mul_f32 v[38:39], v[46:47], v[50:51] op_sel_hi:[1,0]
  v_pk_fma_f32 v[32:33], v[40:41], v[52:53], v[32:33] op_sel:[1,0,0] op_sel_hi:[0,0,1] neg_lo:[1,0,0]
  v_pk_fma_f32 v[34:35], v[42:43], v[52:53], v[34:35] op_sel:[1,0,0] op_sel_hi:[0,0,1] neg_lo:[1,0,0]
  v_pk_fma_f32 v[36:37], v[44:45], v[52:53], v[36:37] op_sel:[1,0,0] op_sel_hi:[0,0,1] neg_lo:[1,0,0]
  v_pk_fma_f32 v[38:39], v[46:47], v[52:53], v[38:39] op_sel:[1,0,0] op_sel_hi:[0,0,1] neg_lo:[1,0,0]
  v_cvt_pk_bf16_f32 v146, v40, v42
  v_cvt_pk_bf16_f32 v162, v41, v43
  v_cvt_pk_bf16_f32 v147, v44, v46
  v_cvt_pk_bf16_f32 v163, v45, v47
  v_pk_mul_f32 v[40:41], v[32:33], v[50:51] op_sel_hi:[1,0]
  v_pk_mul_f32 v[42:43], v[34:35], v[50:51] op_sel_hi:[1,0]
  v_pk_mul_f32 v[44:45], v[36:37], v[50:51] op_sel_hi:[1,0]
  v_pk_mul_f32 v[46:47], v[38:39], v[50:51] op_sel_hi:[1,0]
  v_pk_fma_f32 v[40:41], v[32:33], v[52:53], v[40:41] op_sel:[1,0,0] op_sel_hi:[0,0,1] neg_lo:[1,0,0]
  v_pk_fma_f32 v[42:43], v[34:35], v[52:53], v[42:43] op_sel:[1,0,0] op_sel_hi:[0,0,1] neg_lo:[1,0,0]
  v_pk_fma_f32 v[44:45], v[36:37], v[52:53], v[44:45] op_sel:[1,0,0] op_sel_hi:[0,0,1] neg_lo:[1,0,0]
  v_pk_fma_f32 v[46:47], v[38:39], v[52:53], v[46:47] op_sel:[1,0,0] op_sel_hi:[0,0,1] neg_lo:[1,0,0]
  v_cvt_pk_bf16_f32 v148, v32, v34
  v_cvt_pk_bf16_f32 v164, v33, v35
  v_cvt_pk_bf16_f32 v149, v36, v38
  v_cvt_pk_bf16_f32 v165, v37, v39
  s_add_u32 s77, s84, 1
  s_and_b32 s77, s77, 7
  s_lshl_b32 s77, s77, 7
  s_add_u32 m0, s87, 4096
  s_add_u32 s77, s77, s85
  buffer_load_dwordx4 v240, s[48:51], s77 offen offset:0 lds
  buffer_load_dwordx4 v241, s[48:51], s77 offen offset:1024 lds
  buffer_load_dwordx4 v242, s[48:51], s77 offen offset:2048 lds
  buffer_load_dwordx4 v243, s[48:51], s77 offen offset:3072 lds
  s_add_u32 s79, s84, 2
  s_and_b32 s79, s79, 7
  s_mul_i32 s79, s79, 176128
  s_add_u32 m0, s78, 49152
  s_add_u32 s79, s79, s86
  buffer_load_dwordx4 v244, s[52:55], s79 offen offset:0 lds
  buffer_load_dwordx4 v245, s[52:55], s79 offen offset:1024 lds
  buffer_load_dwordx4 v246, s[52:55], s79 offen offset:2048 lds
  v_cvt_pk_bf16_f32 v150, v40, v42
  v_cvt_pk_bf16_f32 v166, v41, v43
  v_cvt_pk_bf16_f32 v151, v44, v46
  v_cvt_pk_bf16_f32 v167, v45, v47
  ds_write_b128 v200, v[136:139]
  ds_write_b128 v201, v[140:143]
  ds_write_b128 v202, v[144:147]
  ds_write_b128 v203, v[148:151]
  ds_write_b128 v204, v[152:155]
  ds_write_b128 v205, v[156:159]
  ds_write_b128 v206, v[160:163]
  ds_write_b128 v207, v[164:167]
  s_mov_b64 exec, 1
  ds_add_u32 v210, v2 offset:68
  s_mov_b64 exec, -1
  s_waitcnt vmcnt(10)
  s_mov_b64 exec, 1
  ds_add_u32 v1, v2 offset:32
  s_mov_b64 exec, -1
  ds_read_b128 v[128:131], v224 offset:0
  ds_read_b128 v[132:135], v225 offset:0
  ds_read_b128 v[136:139], v226 offset:0
  ds_read_b128 v[140:143], v227 offset:0
  ds_read_b32 v3, v1 offset:32
  s_waitcnt lgkmcnt(0)
  v_readfirstlane_b32 s15, v3
  s_nop 0
  s_cmp_ge_u32 s15, 4
  s_cbranch_scc1 L_lwd_62
L_lw_61:
  s_sleep 1
  ds_read_b32 v3, v1 offset:32
  s_sub_u32 s76, s76, 1
  s_waitcnt lgkmcnt(0)
  v_readfirstlane_b32 s15, v3
  s_cmp_lt_i32 s76, 0
  s_cselect_b32 s15, 4, s15
  s_cmp_ge_u32 s15, 4
  s_cbranch_scc0 L_lw_61
L_lwd_62:
  ds_read_b64_tr_b16 v[44:45], v10 offset:24576
  ds_read_b64_tr_b16 v[46:47], v10 offset:24832
  ds_read_b64_tr_b16 v[48:49], v10 offset:25600
  ds_read_b64_tr_b16 v[50:51], v10 offset:25856
  ds_read_b64_tr_b16 v[52:53], v10 offset:26624
  ds_read_b64_tr_b16 v[54:55], v10 offset:26880
  ds_read_b64_tr_b16 v[56:57], v11 offset:24576
  ds_read_b64_tr_b16 v[58:59], v11 offset:24832
  ds_read_b64_tr_b16 v[60:61], v11 offset:25600
  ds_read_b64_tr_b16 v[62:63], v11 offset:25856
  ds_read_b64_tr_b16 v[64:65], v11 offset:26624
  ds_read_b64_tr_b16 v[66:67], v11 offset:26880
  s_waitcnt vmcnt(3)
  s_mov_b64 exec, 1
  ds_add_u32 v1, v2 offset:36
  s_mov_b64 exec, -1
  ds_read_b128 v[144:147], v224 offset:4096
  ds_read_b128 v[148:151], v225 offset:4096
  ds_read_b128 v[152:155], v226 offset:4096
  ds_read_b128 v[156:159], v227 offset:4096
  s_waitcnt lgkmcnt(11)
  v_mfma_f32_32x32x16_bf16 v[80:95], v[44:47], v[128:131], 0
  ds_read_b64_tr_b16 v[68:69], v12 offset:24576
  ds_read_b64_tr_b16 v[70:71], v12 offset:24832
  v_mfma_f32_16x16x32_bf16 v[184:187], v[232:235], v[44:47], 0
  s_add_u32 m0, s87, 0
  s_nop 0
  buffer_load_dwordx4 v240, s[48:51], s18 offen offset:0 lds
  v_mfma_f32_32x32x16_bf16 v[96:111], v[48:51], v[128:131], 0
  ds_read_b64_tr_b16 v[72:73], v12 offset:25600
  ds_read_b64_tr_b16 v[74:75], v12 offset:25856
  buffer_load_dwordx4 v241, s[48:51], s18 offen offset:1024 lds
  v_mfma_f32_32x32x16_bf16 v[112:127], v[52:55], v[128:131], 0
  ds_read_b64_tr_b16 v[76:77], v12 offset:26624
  ds_read_b64_tr_b16 v[78:79], v12 offset:26880
  buffer_load_dwordx4 v242, s[48:51], s18 offen offset:2048 lds
  s_waitcnt lgkmcnt(6)
  ds_read_b32 v173, v1 offset:36
  v_mfma_f32_32x32x16_bf16 v[80:95], v[56:59], v[132:135], v[80:95]
  ds_read_b64_tr_b16 v[44:45], v13 offset:24576
  ds_read_b64_tr_b16 v[46:47], v13 offset:24832
  v_mfma_f32_16x16x32_bf16 v[188:191], v[232:235], v[60:63], 0
  buffer_load_dwordx4 v243, s[48:51], s18 offen offset:3072 lds
  v_mfma_f32_32x32x16_bf16 v[96:111], v[60:63], v[132:135], v[96:111]
  ds_read_b64_tr_b16 v[48:49], v13 offset:25600
  ds_read_b64_tr_b16 v[50:51], v13 offset:25856
  s_add_u32 m0, s78, 0
  s_nop 0
  buffer_load_dwordx4 v244, s[52:55], s27 offen offset:0 lds
  v_mfma_f32_32x32x16_bf16 v[112:127], v[64:67], v[132:135], v[112:127]
  ds_read_b64_tr_b16 v[52:53], v13 offset:26624
  ds_read_b64_tr_b16 v[54:55], v13 offset:26880
  buffer_load_dwordx4 v245, s[52:55], s27 offen offset:1024 lds
  s_waitcnt lgkmcnt(6)
  v_readfirstlane_b32 s15, v173
  s_nop 0
  s_cmp_ge_u32 s15, 4
  s_cbranch_scc1 L_lwd_64
L_lw_63:
  s_sleep 1
  ds_read_b32 v173, v1 offset:36
  s_sub_u32 s76, s76, 1
  s_waitcnt lgkmcnt(0)
  v_readfirstlane_b32 s15, v173
  s_cmp_lt_i32 s76, 0
  s_cselect_b32 s15, 4, s15
  s_cmp_ge_u32 s15, 4
  s_cbranch_scc0 L_lw_63
L_lwd_64:
  v_mfma_f32_32x32x16_bf16 v[80:95], v[68:71], v[136:139], v[80:95]
  ds_read_b64_tr_b16 v[56:57], v10 offset:36864
  ds_read_b64_tr_b16 v[58:59], v10 offset:37120
  v_mfma_f32_16x16x32_bf16 v[192:195], v[232:235], v[76:79], 0
  buffer_load_dwordx4 v246, s[52:55], s27 offen offset:2048 lds
  v_mfma_f32_32x32x16_bf16 v[96:111], v[72:75], v[136:139], v[96:111]
  ds_read_b64_tr_b16 v[60:61], v10 offset:37888
  ds_read_b64_tr_b16 v[62:63], v10 offset:38144
  s_add_u32 m0, s87, 4096
  s_nop 0
  buffer_load_dwordx4 v240, s[48:51], s19 offen offset:0 lds
  v_mfma_f32_32x32x16_bf16 v[112:127], v[76:79], v[136:139], v[112:127]
  ds_read_b64_tr_b16 v[64:65], v10 offset:38912
  ds_read_b64_tr_b16 v[66:67], v10 offset:39168
  buffer_load_dwordx4 v241, s[48:51], s19 offen offset:1024 lds
  s_waitcnt lgkmcnt(6)
  v_mfma_f32_32x32x16_bf16 v[80:95], v[44:47], v[140:143], v[80:95]
  ds_read_b64_tr_b16 v[68:69], v11 offset:36864
  ds_read_b64_tr_b16 v[70:71], v11 offset:37120
  buffer_load_dwordx4 v242, s[48:51], s19 offen offset:2048 lds
  v_mfma_f32_32x32x16_bf16 v[96:111], v[48:51], v[140:143], v[96:111]
  ds_read_b64_tr_b16 v[72:73], v11 offset:37888
  ds_read_b64_tr_b16 v[74:75], v11 offset:38144
  buffer_load_dwordx4 v243, s[48:51], s19 offen offset:3072 lds
  v_mfma_f32_32x32x16_bf16 v[112:127], v[52:55], v[140:143], v[112:127]
  ds_read_b64_tr_b16 v[76:77], v11 offset:38912
  ds_read_b64_tr_b16 v[78:79], v11 offset:39168
  s_waitcnt vmcnt(7)
  s_mov_b64 exec, 1
  ds_add_u32 v1, v2 offset:40
  s_mov_b64 exec, -1
  ds_read_b128 v[128:131], v224 offset:0
  ds_read_b128 v[132:135], v225 offset:0
  ds_read_b128 v[136:139], v226 offset:0
  ds_read_b128 v[140:143], v227 offset:0
  s_waitcnt lgkmcnt(11)
  v_mfma_f32_32x32x16_bf16 v[80:95], v[56:59], v[144:147], v[80:95]
  ds_read_b64_tr_b16 v[44:45], v12 offset:36864
  ds_read_b64_tr_b16 v[46:47], v12 offset:37120
  v_mfma_f32_16x16x32_bf16 v[184:187], v[232:235], v[56:59], v[184:187]
  s_add_u32 m0, s78, 12288
  s_nop 0
  buffer_load_dwordx4 v244, s[52:55], s28 offen offset:0 lds
  v_mfma_f32_32x32x16_bf16 v[96:111], v[60:63], v[144:147], v[96:111]
  ds_read_b64_tr_b16 v[48:49], v12 offset:37888
  ds_read_b64_tr_b16 v[50:51], v12 offset:38144
  buffer_load_dwordx4 v245, s[52:55], s28 offen offset:1024 lds
  v_mfma_f32_32x32x16_bf16 v[112:127], v[64:67], v[144:147], v[112:127]
  ds_read_b64_tr_b16 v[52:53], v12 offset:38912
  ds_read_b64_tr_b16 v[54:55], v12 offset:39168
  s_waitcnt lgkmcnt(6)
  ds_read_b32 v173, v1 offset:40
  v_mfma_f32_32x32x16_bf16 v[80:95], v[68:71], v[148:151], v[80:95]
  ds_read_b64_tr_b16 v[56:57], v13 offset:36864
  ds_read_b64_tr_b16 v[58:59], v13 offset:37120
  v_mfma_f32_16x16x32_bf16 v[188:191], v[232:235], v[72:75], v[188:191]
  buffer_load_dwordx4 v246, s[52:55], s28 offen offset:2048 lds
  v_mfma_f32_32x32x16_bf16 v[96:111], v[72:75], v[148:151], v[96:111]
  ds_read_b64_tr_b16 v[60:61], v13 offset:37888
  ds_read_b64_tr_b16 v[62:63], v13 offset:38144
  v_mfma_f32_32x32x16_bf16 v[112:127], v[76:79], v[148:151], v[112:127]
  ds_read_b64_tr_b16 v[64:65], v13 offset:38912
  ds_read_b64_tr_b16 v[66:67], v13 offset:39168
  s_add_u32 m0, s87, 0
  s_nop 0
  buffer_load_dwordx4 v240, s[48:51], s20 offen offset:0 lds
  s_waitcnt lgkmcnt(6)
  v_readfirstlane_b32 s15, v173
  s_nop 0
  s_cmp_ge_u32 s15, 4
  s_cbranch_scc1 L_lwd_66
L_lw_65:
  s_sleep 1
  ds_read_b32 v173, v1 offset:40
  s_sub_u32 s76, s76, 1
  s_waitcnt lgkmcnt(0)
  v_readfirstlane_b32 s15, v173
  s_cmp_lt_i32 s76, 0
  s_cselect_b32 s15, 4, s15
  s_cmp_ge_u32 s15, 4
  s_cbranch_scc0 L_lw_65
L_lwd_66:
  v_mfma_f32_32x32x16_bf16 v[80:95], v[44:47], v[152:155], v[80:95]
  ds_read_b64_tr_b16 v[68:69], v10 offset:49152
  ds_read_b64_tr_b16 v[70:71], v10 offset:49408
  v_mfma_f32_16x16x32_bf16 v[192:195], v[232:235], v[52:55], v[192:195]
  buffer_load_dwordx4 v241, s[48:51], s20 offen offset:1024 lds
  v_mfma_f32_32x32x16_bf16 v[96:111], v[48:51], v[152:155], v[96:111]
  ds_read_b64_tr_b16 v[72:73], v10 offset:50176
  ds_read_b64_tr_b16 v[74:75], v10 offset:50432
  v_mfma_f32_32x32x16_bf16 v[112:127], v[52:55], v[152:155], v[112:127]
  ds_read_b64_tr_b16 v[76:77], v10 offset:51200
  ds_read_b64_tr_b16 v[78:79], v10 offset:51456
  buffer_load_dwordx4 v242, s[48:51], s20 offen offset:2048 lds
  s_waitcnt lgkmcnt(6)
  v_mfma_f32_32x32x16_bf16 v[80:95], v[56:59], v[156:159], v[80:95]
  ds_read_b64_tr_b16 v[44:45], v11 offset:49152
  ds_read_b64_tr_b16 v[46:47], v11 offset:49408
  v_mfma_f32_32x32x16_bf16 v[96:111], v[60:63], v[156:159], v[96:111]
  ds_read_b64_tr_b16 v[48:49], v11 offset:50176
  ds_read_b64_tr_b16 v[50:51], v11 offset:50432
  buffer_load_dwordx4 v243, s[48:51], s20 offen offset:3072 lds
  v_mfma_f32_32x32x16_bf16 v[112:127], v[64:67], v[156:159], v[112:127]
  ds_read_b64_tr_b16 v[52:53], v11 offset:51200
  ds_read_b64_tr_b16 v[54:55], v11 offset:51456
  s_waitcnt vmcnt(7)
  s_mov_b64 exec, 1
  ds_add_u32 v1, v2 offset:44
  s_mov_b64 exec, -1
  ds_read_b128 v[144:147], v224 offset:4096
  ds_read_b128 v[148:151], v225 offset:4096
  ds_read_b128 v[152:155], v226 offset:4096
  ds_read_b128 v[156:159], v227 offset:4096
  s_waitcnt lgkmcnt(11)
  v_mfma_f32_32x32x16_bf16 v[80:95], v[68:71], v[128:131], v[80:95]
  ds_read_b64_tr_b16 v[56:57], v12 offset:49152
  ds_read_b64_tr_b16 v[58:59], v12 offset:49408
  v_mfma_f32_16x16x32_bf16 v[184:187], v[232:235], v[68:71], v[184:187]
  s_add_u32 m0, s78, 24576
  s_nop 0
  buffer_load_dwordx4 v244, s[52:55], s29 offen offset:0 lds
  v_mfma_f32_32x32x16_bf16 v[96:111], v[72:75], v[128:131], v[96:111]
  ds_read_b64_tr_b16 v[60:61], v12 offset:50176
  ds_read_b64_tr_b16 v[62:63], v12 offset:50432
  buffer_load_dwordx4 v245, s[52:55], s29 offen offset:1024 lds
  v_mfma_f32_32x32x16_bf16 v[112:127], v[76:79], v[128:131], v[112:127]
  ds_read_b64_tr_b16 v[64:65], v12 offset:51200
  ds_read_b64_tr_b16 v[66:67], v12 offset:51456
  s_waitcnt lgkmcnt(6)
  ds_read_b32 v173, v1 offset:44
  v_mfma_f32_32x32x16_bf16 v[80:95], v[44:47], v[132:135], v[80:95]
  ds_read_b64_tr_b16 v[68:69], v13 offset:49152
  ds_read_b64_tr_b16 v[70:71], v13 offset:49408
  v_mfma_f32_16x16x32_bf16 v[188:191], v[232:235], v[48:51], v[188:191]
  buffer_load_dwordx4 v246, s[52:55], s29 offen offset:2048 lds
  v_mfma_f32_32x32x16_bf16 v[96:111], v[48:51], v[132:135], v[96:111]
  ds_read_b64_tr_b16 v[72:73], v13 offset:50176
  ds_read_b64_tr_b16 v[74:75], v13 offset:50432
  v_mfma_f32_32x32x16_bf16 v[112:127], v[52:55], v[132:135], v[112:127]
  ds_read_b64_tr_b16 v[76:77], v13 offset:51200
  ds_read_b64_tr_b16 v[78:79], v13 offset:51456
  s_add_u32 m0, s87, 4096
  s_nop 0
  buffer_load_dwordx4 v240, s[48:51], s21 offen offset:0 lds
  s_waitcnt lgkmcnt(6)
  v_readfirstlane_b32 s15, v173
  s_nop 0
  s_cmp_ge_u32 s15, 4
  s_cbranch_scc1 L_lwd_68
L_lw_67:
  s_sleep 1
  ds_read_b32 v173, v1 offset:44
  s_sub_u32 s76, s76, 1
  s_waitcnt lgkmcnt(0)
  v_readfirstlane_b32 s15, v173
  s_cmp_lt_i32 s76, 0
  s_cselect_b32 s15, 4, s15
  s_cmp_ge_u32 s15, 4
  s_cbranch_scc0 L_lw_67
L_lwd_68:
  v_mfma_f32_32x32x16_bf16 v[80:95], v[56:59], v[136:139], v[80:95]
  ds_read_b64_tr_b16 v[44:45], v10 offset:0
  ds_read_b64_tr_b16 v[46:47], v10 offset:256
  v_mfma_f32_16x16x32_bf16 v[192:195], v[232:235], v[64:67], v[192:195]
  buffer_load_dwordx4 v241, s[48:51], s21 offen offset:1024 lds
  v_mfma_f32_32x32x16_bf16 v[96:111], v[60:63], v[136:139], v[96:111]
  ds_read_b64_tr_b16 v[48:49], v10 offset:1024
  ds_read_b64_tr_b16 v[50:51], v10 offset:1280
  v_mfma_f32_32x32x16_bf16 v[112:127], v[64:67], v[136:139], v[112:127]
  ds_read_b64_tr_b16 v[52:53], v10 offset:2048
  ds_read_b64_tr_b16 v[54:55], v10 offset:2304
  buffer_load_dwordx4 v242, s[48:51], s21 offen offset:2048 lds
  s_waitcnt lgkmcnt(6)
  v_mfma_f32_32x32x16_bf16 v[80:95], v[68:71], v[140:143], v[80:95]
  ds_read_b64_tr_b16 v[56:57], v11 offset:0
  ds_read_b64_tr_b16 v[58:59], v11 offset:256
  v_mfma_f32_32x32x16_bf16 v[96:111], v[72:75], v[140:143], v[96:111]
  ds_read_b64_tr_b16 v[60:61], v11 offset:1024
  ds_read_b64_tr_b16 v[62:63], v11 offset:1280
  buffer_load_dwordx4 v243, s[48:51], s21 offen offset:3072 lds
  v_mfma_f32_32x32x16_bf16 v[112:127], v[76:79], v[140:143], v[112:127]
  ds_read_b64_tr_b16 v[64:65], v11 offset:2048
  ds_read_b64_tr_b16 v[66:67], v11 offset:2304
  s_waitcnt vmcnt(7)
  s_mov_b64 exec, 1
  ds_add_u32 v1, v2 offset:48
  s_mov_b64 exec, -1
  ds_read_b128 v[128:131], v224 offset:0
  ds_read_b128 v[132:135], v225 offset:0
  ds_read_b128 v[136:139], v226 offset:0
  ds_read_b128 v[140:143], v227 offset:0
  s_waitcnt lgkmcnt(11)
  v_mfma_f32_32x32x16_bf16 v[80:95], v[44:47], v[144:147], v[80:95]
  ds_read_b64_tr_b16 v[68:69], v12 offset:0
  ds_read_b64_tr_b16 v[70:71], v12 offset:256
  v_mfma_f32_16x16x32_bf16 v[184:187], v[232:235], v[44:47], v[184:187]
  s_add_u32 m0, s78, 36864
  s_nop 0
  buffer_load_dwordx4 v244, s[52:55], s30 offen offset:0 lds
  v_mfma_f32_32x32x16_bf16 v[96:111], v[48:51], v[144:147], v[96:111]
  ds_read_b64_tr_b16 v[72:73], v12 offset:1024
  ds_read_b64_tr_b16 v[74:75], v12 offset:1280
  buffer_load_dwordx4 v245, s[52:55], s30 offen offset:1024 lds
  v_mfma_f32_32x32x16_bf16 v[112:127], v[52:55], v[144:147], v[112:127]
  ds_read_b64_tr_b16 v[76:77], v12 offset:2048
  ds_read_b64_tr_b16 v[78:79], v12 offset:2304
  s_waitcnt lgkmcnt(6)
  ds_read_b32 v173, v1 offset:48
  v_mfma_f32_32x32x16_bf16 v[80:95], v[56:59], v[148:151], v[80:95]
  ds_read_b64_tr_b16 v[44:45], v13 offset:0
  ds_read_b64_tr_b16 v[46:47], v13 offset:256
  v_mfma_f32_16x16x32_bf16 v[188:191], v[232:235], v[60:63], v[188:191]
  buffer_load_dwordx4 v246, s[52:55], s30 offen offset:2048 lds
  v_mfma_f32_32x32x16_bf16 v[96:111], v[60:63], v[148:151], v[96:111]
  ds_read_b64_tr_b16 v[48:49], v13 offset:1024
  ds_read_b64_tr_b16 v[50:51], v13 offset:1280
  v_mfma_f32_32x32x16_bf16 v[112:127], v[64:67], v[148:151], v[112:127]
  ds_read_b64_tr_b16 v[52:53], v13 offset:2048
  ds_read_b64_tr_b16 v[54:55], v13 offset:2304
  s_add_u32 m0, s87, 0
  s_nop 0
  buffer_load_dwordx4 v240, s[48:51], s22 offen offset:0 lds
  s_waitcnt lgkmcnt(6)
  v_readfirstlane_b32 s15, v173
  s_nop 0
  s_cmp_ge_u32 s15, 4
  s_cbranch_scc1 L_lwd_70
L_lw_69:
  s_sleep 1
  ds_read_b32 v173, v1 offset:48
  s_sub_u32 s76, s76, 1
  s_waitcnt lgkmcnt(0)
  v_readfirstlane_b32 s15, v173
  s_cmp_lt_i32 s76, 0
  s_cselect_b32 s15, 4, s15
  s_cmp_ge_u32 s15, 4
  s_cbranch_scc0 L_lw_69
L_lwd_70:
  v_mfma_f32_32x32x16_bf16 v[80:95], v[68:71], v[152:155], v[80:95]
  ds_read_b64_tr_b16 v[56:57], v10 offset:12288
  ds_read_b64_tr_b16 v[58:59], v10 offset:12544
  v_mfma_f32_16x16x32_bf16 v[192:195], v[232:235], v[76:79], v[192:195]
  buffer_load_dwordx4 v241, s[48:51], s22 offen offset:1024 lds
  v_mfma_f32_32x32x16_bf16 v[96:111], v[72:75], v[152:155], v[96:111]
  ds_read_b64_tr_b16 v[60:61], v10 offset:13312
  ds_read_b64_tr_b16 v[62:63], v10 offset:13568
  v_mfma_f32_32x32x16_bf16 v[112:127], v[76:79], v[152:155], v[112:127]
  ds_read_b64_tr_b16 v[64:65], v10 offset:14336
  ds_read_b64_tr_b16 v[66:67], v10 offset:14592
  buffer_load_dwordx4 v242, s[48:51], s22 offen offset:2048 lds
  s_waitcnt lgkmcnt(6)
  v_mfma_f32_32x32x16_bf16 v[80:95], v[44:47], v[156:159], v[80:95]
  ds_read_b64_tr_b16 v[68:69], v11 offset:12288
  ds_read_b64_tr_b16 v[70:71], v11 offset:12544
  v_mfma_f32_32x32x16_bf16 v[96:111], v[48:51], v[156:159], v[96:111]
  ds_read_b64_tr_b16 v[72:73], v11 offset:13312
  ds_read_b64_tr_b16 v[74:75], v11 offset:13568
  buffer_load_dwordx4 v243, s[48:51], s22 offen offset:3072 lds
  v_mfma_f32_32x32x16_bf16 v[112:127], v[52:55], v[156:159], v[112:127]
  ds_read_b64_tr_b16 v[76:77], v11 offset:14336
  ds_read_b64_tr_b16 v[78:79], v11 offset:14592
  s_waitcnt vmcnt(7)
  s_mov_b64 exec, 1
  ds_add_u32 v1, v2 offset:52
  s_mov_b64 exec, -1
  ds_read_b128 v[144:147], v224 offset:4096
  ds_read_b128 v[148:151], v225 offset:4096
  ds_read_b128 v[152:155], v226 offset:4096
  ds_read_b128 v[156:159], v227 offset:4096
  s_waitcnt lgkmcnt(11)
  v_mfma_f32_32x32x16_bf16 v[80:95], v[56:59], v[128:131], v[80:95]
  ds_read_b64_tr_b16 v[44:45], v12 offset:12288
  ds_read_b64_tr_b16 v[46:47], v12 offset:12544
  v_mfma_f32_16x16x32_bf16 v[184:187], v[232:235], v[56:59], v[184:187]
  s_add_u32 m0, s78, 49152
  s_nop 0
  buffer_load_dwordx4 v244, s[52:55], s31 offen offset:0 lds
  v_mfma_f32_32x32x16_bf16 v[96:111], v[60:63], v[128:131], v[96:111]
  ds_read_b64_tr_b16 v[48:49], v12 offset:13312
  ds_read_b64_tr_b16 v[50:51], v12 offset:13568
  buffer_load_dwordx4 v245, s[52:55], s31 offen offset:1024 lds
  v_mfma_f32_32x32x16_bf16 v[112:127], v[64:67], v[128:131], v[112:127]
  ds_read_b64_tr_b16 v[52:53], v12 offset:14336
  ds_read_b64_tr_b16 v[54:55], v12 offset:14592
  buffer_load_dwordx4 v246, s[52:55], s31 offen offset:2048 lds
  s_waitcnt lgkmcnt(6)
  ds_read_b32 v173, v1 offset:52
  v_mfma_f32_32x32x16_bf16 v[80:95], v[68:71], v[132:135], v[80:95]
  ds_read_b64_tr_b16 v[56:57], v13 offset:12288
  ds_read_b64_tr_b16 v[58:59], v13 offset:12544
  v_mfma_f32_16x16x32_bf16 v[188:191], v[232:235], v[72:75], v[188:191]
  v_mfma_f32_32x32x16_bf16 v[96:111], v[72:75], v[132:135], v[96:111]
  ds_read_b64_tr_b16 v[60:61], v13 offset:13312
  ds_read_b64_tr_b16 v[62:63], v13 offset:13568
  s_add_u32 m0, s87, 4096
  s_nop 0
  buffer_load_dwordx4 v240, s[48:51], s23 offen offset:0 lds
  v_mfma_f32_32x32x16_bf16 v[112:127], v[76:79], v[132:135], v[112:127]
  ds_read_b64_tr_b16 v[64:65], v13 offset:14336
  ds_read_b64_tr_b16 v[66:67], v13 offset:14592
  buffer_load_dwordx4 v241, s[48:51], s23 offen offset:1024 lds
  s_waitcnt lgkmcnt(6)
  v_readfirstlane_b32 s15, v173
  s_nop 0
  s_cmp_ge_u32 s15, 4
  s_cbranch_scc1 L_lwd_72
L_lw_71:
  s_sleep 1
  ds_read_b32 v173, v1 offset:52
  s_sub_u32 s76, s76, 1
  s_waitcnt lgkmcnt(0)
  v_readfirstlane_b32 s15, v173
  s_cmp_lt_i32 s76, 0
  s_cselect_b32 s15, 4, s15
  s_cmp_ge_u32 s15, 4
  s_cbranch_scc0 L_lw_71
L_lwd_72:
  v_mfma_f32_32x32x16_bf16 v[80:95], v[44:47], v[136:139], v[80:95]
  ds_read_b64_tr_b16 v[68:69], v10 offset:24576
  ds_read_b64_tr_b16 v[70:71], v10 offset:24832
  v_mfma_f32_16x16x32_bf16 v[192:195], v[232:235], v[52:55], v[192:195]
  buffer_load_dwordx4 v242, s[48:51], s23 offen offset:2048 lds
  v_mfma_f32_32x32x16_bf16 v[96:111], v[48:51], v[136:139], v[96:111]
  ds_read_b64_tr_b16 v[72:73], v10 offset:25600
  ds_read_b64_tr_b16 v[74:75], v10 offset:25856
  v_mfma_f32_32x32x16_bf16 v[112:127], v[52:55], v[136:139], v[112:127]
  ds_read_b64_tr_b16 v[76:77], v10 offset:26624
  ds_read_b64_tr_b16 v[78:79], v10 offset:26880
  buffer_load_dwordx4 v243, s[48:51], s23 offen offset:3072 lds
  s_waitcnt lgkmcnt(6)
  v_mfma_f32_32x32x16_bf16 v[80:95], v[56:59], v[140:143], v[80:95]
  ds_read_b64_tr_b16 v[44:45], v11 offset:24576
  ds_read_b64_tr_b16 v[46:47], v11 offset:24832
  buffer_load_dword v5, v1, s[72:75], 0 offen sc1
  v_mfma_f32_32x32x16_bf16 v[96:111], v[60:63], v[140:143], v[96:111]
  ds_read_b64_tr_b16 v[48:49], v11 offset:25600
  ds_read_b64_tr_b16 v[50:51], v11 offset:25856
  buffer_load_dwordx4 v[168:171], v228, s[44:47], s93 offen sc1
  v_mfma_f32_32x32x16_bf16 v[112:127], v[64:67], v[140:143], v[112:127]
  ds_read_b64_tr_b16 v[52:53], v11 offset:26624
  ds_read_b64_tr_b16 v[54:55], v11 offset:26880
  s_waitcnt vmcnt(9)
  s_mov_b64 exec, 1
  ds_add_u32 v1, v2 offset:56
  s_mov_b64 exec, -1
  ds_read_b128 v[128:131], v224 offset:0
  ds_read_b128 v[132:135], v225 offset:0
  ds_read_b128 v[136:139], v226 offset:0
  ds_read_b128 v[140:143], v227 offset:0
  s_waitcnt lgkmcnt(11)
  v_mfma_f32_32x32x16_bf16 v[80:95], v[68:71], v[144:147], v[80:95]
  ds_read_b64_tr_b16 v[56:57], v12 offset:24576
  ds_read_b64_tr_b16 v[58:59], v12 offset:24832
  v_mfma_f32_16x16x32_bf16 v[184:187], v[232:235], v[68:71], v[184:187]
  v_mfma_f32_32x32x16_bf16 v[96:111], v[72:75], v[144:147], v[96:111]
  ds_read_b64_tr_b16 v[60:61], v12 offset:25600
  ds_read_b64_tr_b16 v[62:63], v12 offset:25856
  v_mfma_f32_32x32x16_bf16 v[112:127], v[76:79], v[144:147], v[112:127]
  ds_read_b64_tr_b16 v[64:65], v12 offset:26624
  ds_read_b64_tr_b16 v[66:67], v12 offset:26880
  s_waitcnt lgkmcnt(6)
  ds_read_b32 v173, v1 offset:56
  v_mfma_f32_32x32x16_bf16 v[80:95], v[44:47], v[148:151], v[80:95]
  ds_read_b64_tr_b16 v[68:69], v13 offset:24576
  ds_read_b64_tr_b16 v[70:71], v13 offset:24832
  v_mfma_f32_16x16x32_bf16 v[188:191], v[232:235], v[48:51], v[188:191]
  v_mfma_f32_32x32x16_bf16 v[96:111], v[48:51], v[148:151], v[96:111]
  ds_read_b64_tr_b16 v[72:73], v13 offset:25600
  ds_read_b64_tr_b16 v[74:75], v13 offset:25856
  v_mfma_f32_32x32x16_bf16 v[112:127], v[52:55], v[148:151], v[112:127]
  ds_read_b64_tr_b16 v[76:77], v13 offset:26624
  ds_read_b64_tr_b16 v[78:79], v13 offset:26880
  s_waitcnt lgkmcnt(6)
  v_readfirstlane_b32 s15, v173
  s_nop 0
  s_cmp_ge_u32 s15, 4
  s_cbranch_scc1 L_lwd_74
L_lw_73:
  s_sleep 1
  ds_read_b32 v173, v1 offset:56
  s_sub_u32 s76, s76, 1
  s_waitcnt lgkmcnt(0)
  v_readfirstlane_b32 s15, v173
  s_cmp_lt_i32 s76, 0
  s_cselect_b32 s15, 4, s15
  s_cmp_ge_u32 s15, 4
  s_cbranch_scc0 L_lw_73
L_lwd_74:
  v_mfma_f32_32x32x16_bf16 v[80:95], v[56:59], v[152:155], v[80:95]
  ds_read_b64_tr_b16 v[44:45], v10 offset:36864
  ds_read_b64_tr_b16 v[46:47], v10 offset:37120
  v_mfma_f32_16x16x32_bf16 v[192:195], v[232:235], v[64:67], v[192:195]
  v_mfma_f32_32x32x16_bf16 v[96:111], v[60:63], v[152:155], v[96:111]
  ds_read_b64_tr_b16 v[48:49], v10 offset:37888
  ds_read_b64_tr_b16 v[50:51], v10 offset:38144
  v_mfma_f32_32x32x16_bf16 v[112:127], v[64:67], v[152:155], v[112:127]
  ds_read_b64_tr_b16 v[52:53], v10 offset:38912
  ds_read_b64_tr_b16 v[54:55], v10 offset:39168
  s_waitcnt lgkmcnt(6)
  v_mfma_f32_32x32x16_bf16 v[80:95], v[68:71], v[156:159], v[80:95]
  ds_read_b64_tr_b16 v[56:57], v11 offset:36864
  ds_read_b64_tr_b16 v[58:59], v11 offset:37120
  v_mfma_f32_32x32x16_bf16 v[96:111], v[72:75], v[156:159], v[96:111]
  ds_read_b64_tr_b16 v[60:61], v11 offset:37888
  ds_read_b64_tr_b16 v[62:63], v11 offset:38144
  v_mfma_f32_32x32x16_bf16 v[112:127], v[76:79], v[156:159], v[112:127]
  ds_read_b64_tr_b16 v[64:65], v11 offset:38912
  ds_read_b64_tr_b16 v[66:67], v11 offset:39168
  s_waitcnt vmcnt(2)
  s_mov_b64 exec, 1
  ds_add_u32 v1, v2 offset:60
  s_mov_b64 exec, -1
  ds_read_b128 v[144:147], v224 offset:4096
  ds_read_b128 v[148:151], v225 offset:4096
  ds_read_b128 v[152:155], v226 offset:4096
  ds_read_b128 v[156:159], v227 offset:4096
  s_waitcnt lgkmcnt(11)
  v_mfma_f32_32x32x16_bf16 v[80:95], v[44:47], v[128:131], v[80:95]
  ds_read_b64_tr_b16 v[68:69], v12 offset:36864
  ds_read_b64_tr_b16 v[70:71], v12 offset:37120
  v_mfma_f32_16x16x32_bf16 v[184:187], v[232:235], v[44:47], v[184:187]
  v_mfma_f32_32x32x16_bf16 v[96:111], v[48:51], v[128:131], v[96:111]
  ds_read_b64_tr_b16 v[72:73], v12 offset:37888
  ds_read_b64_tr_b16 v[74:75], v12 offset:38144
  v_mfma_f32_32x32x16_bf16 v[112:127], v[52:55], v[128:131], v[112:127]
  ds_read_b64_tr_b16 v[76:77], v12 offset:38912
  ds_read_b64_tr_b16 v[78:79], v12 offset:39168
  s_waitcnt lgkmcnt(6)
  ds_read_b32 v173, v1 offset:60
  s_waitcnt vmcnt(0)
  v_readfirstlane_b32 s14, v5
  s_nop 0
  s_cmp_lg_u32 s14, 0
  s_cbranch_scc1 L_nwd_76
L_nw_75:
  buffer_load_dword v5, v1, s[72:75], 0 offen sc1
  s_sub_u32 s76, s76, 1
  s_waitcnt vmcnt(0)
  v_readfirstlane_b32 s14, v5
  s_cmp_lt_i32 s76, 0
  s_cselect_b32 s14, 1, s14
  s_cmp_lg_u32 s14, 0
  s_cbranch_scc0 L_nw_75
L_nwd_76:
  s_waitcnt vmcnt(0)
  v_cmp_ne_u32 s[98:99], s14, v168
  v_cmp_ne_u32 vcc, s14, v170
  s_nop 0
  s_or_b64 vcc, vcc, s[98:99]
  s_cbranch_vccz L_pd_78
  s_mov_b64 exec, vcc
L_p_77:
  s_sleep 4
  buffer_load_dwordx4 v[168:171], v228, s[44:47], s93 offen sc1
  s_sub_u32 s76, s76, 1
  s_waitcnt vmcnt(0)
  v_cmp_ne_u32 s[98:99], s14, v168
  v_cmp_ne_u32 vcc, s14, v170
  s_nop 0
  s_or_b64 vcc, vcc, s[98:99]
  s_cmp_gt_i32 s76, 0
  s_cselect_b64 exec, vcc, 0
  s_cbranch_execnz L_p_77
L_pd_78:
  s_mov_b64 exec, -1
  v_and_b32 v3, 1, v0
  v_lshlrev_b32 v3, 4, v3
  v_lshrrev_b32 v3, v3, v169
  v_and_b32 v3, 0xffff, v3
  v_lshl_or_b32 v180, v3, 16, v3
  v_lshl_or_b32 v181, v3, 16, v3
  v_lshl_or_b32 v182, v3, 16, v3
  v_lshl_or_b32 v183, v3, 16, v3
  v_mfma_f32_32x32x16_bf16 v[80:95], v[56:59], v[132:135], v[80:95]
  ds_read_b64_tr_b16 v[44:45], v13 offset:36864
  ds_read_b64_tr_b16 v[46:47], v13 offset:37120
  v_mfma_f32_16x16x32_bf16 v[188:191], v[232:235], v[60:63], v[188:191]
  v_mfma_f32_32x32x16_bf16 v[96:111], v[60:63], v[132:135], v[96:111]
  ds_read_b64_tr_b16 v[48:49], v13 offset:37888
  ds_read_b64_tr_b16 v[50:51], v13 offset:38144
  v_mfma_f32_32x32x16_bf16 v[112:127], v[64:67], v[132:135], v[112:127]
  ds_read_b64_tr_b16 v[52:53], v13 offset:38912
  ds_read_b64_tr_b16 v[54:55], v13 offset:39168
  s_waitcnt lgkmcnt(6)
  v_readfirstlane_b32 s15, v173
  s_nop 0
  s_cmp_ge_u32 s15, 4
  s_cbranch_scc1 L_lwd_80
L_lw_79:
  s_sleep 1
  ds_read_b32 v173, v1 offset:60
  s_sub_u32 s76, s76, 1
  s_waitcnt lgkmcnt(0)
  v_readfirstlane_b32 s15, v173
  s_cmp_lt_i32 s76, 0
  s_cselect_b32 s15, 4, s15
  s_cmp_ge_u32 s15, 4
  s_cbranch_scc0 L_lw_79
L_lwd_80:
  v_mfma_f32_32x32x16_bf16 v[80:95], v[68:71], v[136:139], v[80:95]
  ds_read_b64_tr_b16 v[56:57], v10 offset:49152
  ds_read_b64_tr_b16 v[58:59], v10 offset:49408
  v_mfma_f32_16x16x32_bf16 v[192:195], v[232:235], v[76:79], v[192:195]
  v_mfma_f32_32x32x16_bf16 v[96:111], v[72:75], v[136:139], v[96:111]
  ds_read_b64_tr_b16 v[60:61], v10 offset:50176
  ds_read_b64_tr_b16 v[62:63], v10 offset:50432
  v_mfma_f32_32x32x16_bf16 v[112:127], v[76:79], v[136:139], v[112:127]
  ds_read_b64_tr_b16 v[64:65], v10 offset:51200
  ds_read_b64_tr_b16 v[66:67], v10 offset:51456
  s_waitcnt lgkmcnt(6)
  v_mfma_f32_32x32x16_bf16 v[80:95], v[44:47], v[140:143], v[80:95]
  ds_read_b64_tr_b16 v[68:69], v11 offset:49152
  ds_read_b64_tr_b16 v[70:71], v11 offset:49408
  v_mfma_f32_32x32x16_bf16 v[96:111], v[48:51], v[140:143], v[96:111]
  ds_read_b64_tr_b16 v[72:73], v11 offset:50176
  ds_read_b64_tr_b16 v[74:75], v11 offset:50432
  v_mfma_f32_32x32x16_bf16 v[112:127], v[52:55], v[140:143], v[112:127]
  ds_read_b64_tr_b16 v[76:77], v11 offset:51200
  ds_read_b64_tr_b16 v[78:79], v11 offset:51456
  s_waitcnt lgkmcnt(6)
  v_mfma_f32_32x32x16_bf16 v[80:95], v[56:59], v[144:147], v[80:95]
  ds_read_b64_tr_b16 v[44:45], v12 offset:49152
  ds_read_b64_tr_b16 v[46:47], v12 offset:49408
  v_mfma_f32_16x16x32_bf16 v[184:187], v[232:235], v[56:59], v[184:187]
  v_mfma_f32_32x32x16_bf16 v[96:111], v[60:63], v[144:147], v[96:111]
  ds_read_b64_tr_b16 v[48:49], v12 offset:50176
  ds_read_b64_tr_b16 v[50:51], v12 offset:50432
  v_mfma_f32_16x16x32_bf16 v[188:191], v[232:235], v[60:63], v[188:191]
  v_mfma_f32_32x32x16_bf16 v[112:127], v[64:67], v[144:147], v[112:127]
  ds_read_b64_tr_b16 v[52:53], v12 offset:51200
  ds_read_b64_tr_b16 v[54:55], v12 offset:51456
  v_mfma_f32_16x16x32_bf16 v[192:195], v[232:235], v[64:67], v[192:195]
  s_waitcnt lgkmcnt(6)
  v_mfma_f32_32x32x16_bf16 v[80:95], v[68:71], v[148:151], v[80:95]
  ds_read_b64_tr_b16 v[56:57], v13 offset:49152
  ds_read_b64_tr_b16 v[58:59], v13 offset:49408
  v_cvt_pk_bf16_f32 v3, v184, v185
  v_lshlrev_b32_e64 v236, 16, v3
  v_and_b32 v3, 0xffff0000, v3
  v_sub_f32 v236, v184, v236
  v_sub_f32 v3, v185, v3
  v_cvt_pk_bf16_f32 v184, v184, v236
  v_cvt_pk_bf16_f32 v185, v185, v3
  v_mfma_f32_32x32x16_bf16 v[96:111], v[72:75], v[148:151], v[96:111]
  ds_read_b64_tr_b16 v[60:61], v13 offset:50176
  ds_read_b64_tr_b16 v[62:63], v13 offset:50432
  v_cvt_pk_bf16_f32 v3, v188, v189
  v_lshlrev_b32_e64 v236, 16, v3
  v_and_b32 v3, 0xffff0000, v3
  v_sub_f32 v236, v188, v236
  v_sub_f32 v3, v189, v3
  v_cvt_pk_bf16_f32 v188, v188, v236
  v_cvt_pk_bf16_f32 v189, v189, v3
  v_mfma_f32_32x32x16_bf16 v[112:127], v[76:79], v[148:151], v[112:127]
  ds_read_b64_tr_b16 v[64:65], v13 offset:51200
  ds_read_b64_tr_b16 v[66:67], v13 offset:51456
  v_cvt_pk_bf16_f32 v3, v192, v193
  v_lshlrev_b32_e64 v236, 16, v3
  v_and_b32 v3, 0xffff0000, v3
  v_sub_f32_e64 v236, v192, v236
  v_sub_f32 v3, v193, v3
  v_cvt_pk_bf16_f32 v192, v192, v236
  v_cvt_pk_bf16_f32 v193, v193, v3
  s_mov_b64 exec, 0xffff
  ds_write2st64_b32 v14, v184, v185 offset0:0 offset1:2
  ds_write2st64_b32 v14, v188, v189 offset0:4 offset1:6
  ds_write2st64_b32 v14, v192, v193 offset0:8 offset1:10
  s_mov_b64 exec, 1
  ds_add_u32 v1, v2 offset:28
  s_mov_b64 exec, -1
  s_waitcnt lgkmcnt(10)
  v_mfma_f32_32x32x16_bf16 v[80:95], v[44:47], v[152:155], v[80:95]
  v_mfma_f32_32x32x16_bf16 v[96:111], v[48:51], v[152:155], v[96:111]
  v_mfma_f32_32x32x16_bf16 v[112:127], v[52:55], v[152:155], v[112:127]
  ds_read_b32 v173, v1 offset:28
  s_waitcnt lgkmcnt(1)
  s_mov_b64 exec, 1
  ds_add_u32 v1, v2 offset:24
  s_mov_b64 exec, -1
  s_waitcnt lgkmcnt(1)
  v_readfirstlane_b32 s15, v173
  s_nop 0
  s_cmp_ge_u32 s15, 4
  s_cbranch_scc1 L_lwd_82
L_lw_81:
  s_sleep 1
  ds_read_b32 v173, v1 offset:28
  s_sub_u32 s76, s76, 1
  s_waitcnt lgkmcnt(0)
  v_readfirstlane_b32 s15, v173
  s_cmp_lt_i32 s76, 0
  s_cselect_b32 s15, 4, s15
  s_cmp_ge_u32 s15, 4
  s_cbranch_scc0 L_lw_81
L_lwd_82:
  ds_read_b128 v[68:71], v229 offset:0
  ds_read_b128 v[72:75], v229 offset:1024
  ds_read_b128 v[76:79], v229 offset:2048
  v_mfma_f32_32x32x16_bf16 v[80:95], v[56:59], v[156:159], v[80:95]
  v_mfma_f32_32x32x16_bf16 v[96:111], v[60:63], v[156:159], v[96:111]
  v_mfma_f32_32x32x16_bf16 v[112:127], v[64:67], v[156:159], v[112:127]
  s_waitcnt lgkmcnt(2)
  v_mfma_f32_32x32x16_bf16 v[80:95], v[68:71], v[180:183], v[80:95]
  s_waitcnt lgkmcnt(1)
  v_mfma_f32_32x32x16_bf16 v[96:111], v[72:75], v[180:183], v[96:111]
  s_waitcnt lgkmcnt(0)
  v_mfma_f32_32x32x16_bf16 v[112:127], v[76:79], v[180:183], v[112:127]
  s_nop 7
  v_cvt_pk_bf16_f32 v16, v80, v81
  v_cvt_pk_bf16_f32 v17, v82, v83
  v_cvt_pk_bf16_f32 v18, v84, v85
  v_cvt_pk_bf16_f32 v19, v86, v87
  v_pk_max_i16 v16, v16, 0
  v_pk_max_i16 v17, v17, 0
  v_pk_max_i16 v18, v18, 0
  v_pk_max_i16 v19, v19, 0
  buffer_store_dwordx4 v[16:19], v4, s[44:47], s64 offen offset:0 sc1
  v_cvt_pk_bf16_f32 v20, v88, v89
  v_cvt_pk_bf16_f32 v21, v90, v91
  v_cvt_pk_bf16_f32 v22, v92, v93
  v_cvt_pk_bf16_f32 v23, v94, v95
  v_pk_max_i16 v20, v20, 0
  v_pk_max_i16 v21, v21, 0
  v_pk_max_i16 v22, v22, 0
  v_pk_max_i16 v23, v23, 0
  buffer_store_dwordx4 v[20:23], v4, s[44:47], s64 offen offset:1024 sc1
  v_cvt_pk_bf16_f32 v24, v96, v97
  v_cvt_pk_bf16_f32 v25, v98, v99
  v_cvt_pk_bf16_f32 v26, v100, v101
  v_cvt_pk_bf16_f32 v27, v102, v103
  v_pk_max_i16 v24, v24, 0
  v_pk_max_i16 v25, v25, 0
  v_pk_max_i16 v26, v26, 0
  v_pk_max_i16 v27, v27, 0
  buffer_store_dwordx4 v[24:27], v4, s[44:47], s64 offen offset:2048 sc1
  v_cvt_pk_bf16_f32 v28, v104, v105
  v_cvt_pk_bf16_f32 v29, v106, v107
  v_cvt_pk_bf16_f32 v30, v108, v109
  v_cvt_pk_bf16_f32 v31, v110, v111
  v_pk_max_i16 v28, v28, 0
  v_pk_max_i16 v29, v29, 0
  v_pk_max_i16 v30, v30, 0
  v_pk_max_i16 v31, v31, 0
  buffer_store_dwordx4 v[28:31], v4, s[44:47], s64 offen offset:3072 sc1
  v_cvt_pk_bf16_f32 v32, v112, v113
  v_cvt_pk_bf16_f32 v33, v114, v115
  v_cvt_pk_bf16_f32 v34, v116, v117
  v_cvt_pk_bf16_f32 v35, v118, v119
  v_pk_max_i16 v32, v32, 0
  v_pk_max_i16 v33, v33, 0
  v_pk_max_i16 v34, v34, 0
  v_pk_max_i16 v35, v35, 0
  buffer_store_dwordx4 v[32:35], v4, s[44:47], s65 offen offset:0 sc1
  v_cvt_pk_bf16_f32 v36, v120, v121
  v_cvt_pk_bf16_f32 v37, v122, v123
  v_cvt_pk_bf16_f32 v38, v124, v125
  v_cvt_pk_bf16_f32 v39, v126, v127
  v_pk_max_i16 v36, v36, 0
  v_pk_max_i16 v37, v37, 0
  v_pk_max_i16 v38, v38, 0
  v_pk_max_i16 v39, v39, 0
  buffer_store_dwordx4 v[36:39], v4, s[44:47], s65 offen offset:1024 sc1
  s_mov_b64 exec, 1
  ds_add_u32 v1, v2 offset:92
  s_mov_b64 exec, -1
L_G1done:
  s_mov_b32 s79, s66
  s_mov_b32 s99, s67
  v_mov_b32_e64 v10, v238
  v_mov_b32 v11, v239
  v_add_u32 v12, 65536, v238
  v_add_u32 v13, 65536, v239
  s_lshl_b32 s43, s10, 1
  s_mul_i32 s15, s43, 88064
  s_add_u32 s15, s15, 4194304
  s_add_u32 s64, s40, s15
  s_addc_u32 s65, s41, 0
  s_mov_b32 s66, 88064
  s_mov_b32 s67, 0x20000
  s_xor_b32 s43, s43, 1
  s_mul_i32 s15, s43, 88064
  s_add_u32 s15, s15, 4194304
  s_add_u32 s68, s40, s15
  s_addc_u32 s69, s41, 0
  s_mov_b32 s70, 88064
  s_mov_b32 s71, 0x20000
  s_lshl_b32 s43, s10, 9
  s_lshl_b32 s15, s42, 7
  s_add_u32 s43, s43, s15
  s_add_u32 s43, s43, 12713984
  ds_read_b32 v3, v1 offset:24
  s_waitcnt lgkmcnt(0)
  v_readfirstlane_b32 s15, v3
  s_nop 0
  s_cmp_ge_u32 s15, 4
  s_cbranch_scc1 L_lwd_84
L_lw_83:
  s_sleep 1
  ds_read_b32 v3, v1 offset:24
  s_sub_u32 s76, s76, 1
  s_waitcnt lgkmcnt(0)
  v_readfirstlane_b32 s15, v3
  s_cmp_lt_i32 s76, 0
  s_cselect_b32 s15, 4, s15
  s_cmp_ge_u32 s15, 4
  s_cbranch_scc0 L_lw_83
L_lwd_84:
  s_add_u32 m0, s90, 73728
  s_add_u32 s77, s88, 294912
  buffer_load_dwordx4 v8, s[56:59], s77 offen lds
  buffer_load_dwordx4 v9, s[56:59], s77 offen offset:1024 lds
  s_add_u32 m0, s90, 81920
  s_add_u32 s77, s88, 311296
  buffer_load_dwordx4 v8, s[56:59], s77 offen lds
  buffer_load_dwordx4 v9, s[56:59], s77 offen offset:1024 lds
  s_add_u32 m0, s90, 90112
  s_add_u32 s77, s88, 327680
  buffer_load_dwordx4 v8, s[56:59], s77 offen lds
  buffer_load_dwordx4 v9, s[56:59], s77 offen offset:1024 lds
  s_add_u32 m0, s90, 98304
  s_add_u32 s77, s88, 344064
  buffer_load_dwordx4 v8, s[56:59], s77 offen lds
  buffer_load_dwordx4 v9, s[56:59], s77 offen offset:1024 lds
  ds_read_b32 v3, v1 offset:84
  s_waitcnt lgkmcnt(0)
  v_readfirstlane_b32 s15, v3
  s_nop 0
  s_cmp_ge_u32 s15, 4
  s_cbranch_scc1 L_w2ok
  s_waitcnt vmcnt(8)
  s_mov_b32 s82, s14
  s_atomic_swap s82, s[40:41], s79
  s_and_b32 s15, s7, 7
  s_cmp_lg_u32 s15, 3
  s_cbranch_scc1 L_h1a
  s_mov_b32 s83, s14
  s_atomic_swap s83, s[40:41], s99
L_h1a:
  ds_read_b32 v3, v1 offset:84
  s_waitcnt lgkmcnt(0)
  v_readfirstlane_b32 s15, v3
  s_nop 0
  s_cmp_ge_u32 s15, 4
  s_cbranch_scc1 L_lwd_86
L_lw_85:
  s_sleep 1
  ds_read_b32 v3, v1 offset:84
  s_sub_u32 s76, s76, 1
  s_waitcnt lgkmcnt(0)
  v_readfirstlane_b32 s15, v3
  s_cmp_lt_i32 s76, 0
  s_cselect_b32 s15, 4, s15
  s_cmp_ge_u32 s15, 4
  s_cbranch_scc0 L_lw_85
L_lwd_86:
  ds_read_b64_tr_b16 v[208:209], v10 offset:0
  ds_read_b64_tr_b16 v[210:211], v10 offset:1024
  ds_read_b64_tr_b16 v[212:213], v11 offset:0
  ds_read_b64_tr_b16 v[214:215], v11 offset:1024
  ds_read_b64_tr_b16 v[216:217], v10 offset:8192
  ds_read_b64_tr_b16 v[218:219], v10 offset:9216
  ds_read_b64_tr_b16 v[220:221], v11 offset:8192
  ds_read_b64_tr_b16 v[222:223], v11 offset:9216
  ds_read_b64_tr_b16 v[224:225], v10 offset:16384
  ds_read_b64_tr_b16 v[226:227], v10 offset:17408
  ds_read_b64_tr_b16 v[228:229], v11 offset:16384
  ds_read_b64_tr_b16 v[230:231], v11 offset:17408
  ds_read_b64_tr_b16 v[232:233], v10 offset:24576
  ds_read_b64_tr_b16 v[234:235], v10 offset:25600
  ds_read_b64_tr_b16 v[236:237], v11 offset:24576
  ds_read_b64_tr_b16 v[238:239], v11 offset:25600
  ds_read_b64_tr_b16 v[240:241], v10 offset:32768
  ds_read_b64_tr_b16 v[242:243], v10 offset:33792
  ds_read_b64_tr_b16 v[244:245], v11 offset:32768
  ds_read_b64_tr_b16 v[246:247], v11 offset:33792
  ds_read_b64_tr_b16 v[248:249], v10 offset:40960
  ds_read_b64_tr_b16 v[250:251], v10 offset:41984
  ds_read_b64_tr_b16 v[252:253], v11 offset:40960
  ds_read_b64_tr_b16 v[254:255], v11 offset:41984
  ds_read_b64_tr_b16 v[120:121], v10 offset:49152
  ds_read_b64_tr_b16 v[122:123], v10 offset:50176
  ds_read_b64_tr_b16 v[124:125], v11 offset:49152
  ds_read_b64_tr_b16 v[126:127], v11 offset:50176
  ds_read_b64_tr_b16 v[128:129], v10 offset:57344
  ds_read_b64_tr_b16 v[130:131], v10 offset:58368
  ds_read_b64_tr_b16 v[132:133], v11 offset:57344
  ds_read_b64_tr_b16 v[134:135], v11 offset:58368
  ds_read_b64_tr_b16 v[136:137], v12 offset:0
  ds_read_b64_tr_b16 v[138:139], v12 offset:1024
  ds_read_b64_tr_b16 v[140:141], v13 offset:0
  ds_read_b64_tr_b16 v[142:143], v13 offset:1024
  s_waitcnt lgkmcnt(0)
  s_add_u32 m0, s90, 0
  s_add_u32 s77, s88, 147456
  buffer_load_dwordx4 v8, s[56:59], s77 offen lds
  buffer_load_dwordx4 v9, s[56:59], s77 offen offset:1024 lds
  s_branch L_w2j
L_w2ok:
  ds_read_b64_tr_b16 v[208:209], v10 offset:0
  ds_read_b64_tr_b16 v[210:211], v10 offset:1024
  ds_read_b64_tr_b16 v[212:213], v11 offset:0
  ds_read_b64_tr_b16 v[214:215], v11 offset:1024
  ds_read_b64_tr_b16 v[216:217], v10 offset:8192
  ds_read_b64_tr_b16 v[218:219], v10 offset:9216
  ds_read_b64_tr_b16 v[220:221], v11 offset:8192
  ds_read_b64_tr_b16 v[222:223], v11 offset:9216
  ds_read_b64_tr_b16 v[224:225], v10 offset:16384
  ds_read_b64_tr_b16 v[226:227], v10 offset:17408
  ds_read_b64_tr_b16 v[228:229], v11 offset:16384
  ds_read_b64_tr_b16 v[230:231], v11 offset:17408
  ds_read_b64_tr_b16 v[232:233], v10 offset:24576
  ds_read_b64_tr_b16 v[234:235], v10 offset:25600
  ds_read_b64_tr_b16 v[236:237], v11 offset:24576
  ds_read_b64_tr_b16 v[238:239], v11 offset:25600
  ds_read_b64_tr_b16 v[240:241], v10 offset:32768
  ds_read_b64_tr_b16 v[242:243], v10 offset:33792
  ds_read_b64_tr_b16 v[244:245], v11 offset:32768
  ds_read_b64_tr_b16 v[246:247], v11 offset:33792
  ds_read_b64_tr_b16 v[248:249], v10 offset:40960
  ds_read_b64_tr_b16 v[250:251], v10 offset:41984
  ds_read_b64_tr_b16 v[252:253], v11 offset:40960
  ds_read_b64_tr_b16 v[254:255], v11 offset:41984
  ds_read_b64_tr_b16 v[120:121], v10 offset:49152
  ds_read_b64_tr_b16 v[122:123], v10 offset:50176
  ds_read_b64_tr_b16 v[124:125], v11 offset:49152
  ds_read_b64_tr_b16 v[126:127], v11 offset:50176
  ds_read_b64_tr_b16 v[128:129], v10 offset:57344
  ds_read_b64_tr_b16 v[130:131], v10 offset:58368
  ds_read_b64_tr_b16 v[132:133], v11 offset:57344
  ds_read_b64_tr_b16 v[134:135], v11 offset:58368
  ds_read_b64_tr_b16 v[136:137], v12 offset:0
  ds_read_b64_tr_b16 v[138:139], v12 offset:1024
  ds_read_b64_tr_b16 v[140:141], v13 offset:0
  ds_read_b64_tr_b16 v[142:143], v13 offset:1024
  s_waitcnt lgkmcnt(0)
  s_add_u32 m0, s90, 0
  s_add_u32 s77, s88, 147456
  buffer_load_dwordx4 v8, s[56:59], s77 offen lds
  buffer_load_dwordx4 v9, s[56:59], s77 offen offset:1024 lds
  s_waitcnt vmcnt(10)
  s_mov_b32 s82, s14
  s_atomic_swap s82, s[40:41], s79
  s_and_b32 s15, s7, 7
  s_cmp_lg_u32 s15, 3
  s_cbranch_scc1 L_h1b
  s_mov_b32 s83, s14
  s_atomic_swap s83, s[40:41], s99
L_h1b:
L_w2j:
  s_mov_b32 s60, s36
  s_mov_b32 s61, s37
  s_mov_b32 s62, 2097152
  s_mov_b32 s63, 0x20000
  s_add_u32 m0, s90, 8192
  s_add_u32 s77, s88, 163840
  buffer_load_dwordx4 v8, s[56:59], s77 offen lds
  buffer_load_dwordx4 v9, s[56:59], s77 offen offset:1024 lds
  s_add_u32 m0, s90, 16384
  s_add_u32 s77, s88, 180224
  buffer_load_dwordx4 v8, s[56:59], s77 offen lds
  buffer_load_dwordx4 v9, s[56:59], s77 offen offset:1024 lds
  s_add_u32 m0, s90, 24576
  s_add_u32 s77, s88, 196608
  buffer_load_dwordx4 v8, s[56:59], s77 offen lds
  buffer_load_dwordx4 v9, s[56:59], s77 offen offset:1024 lds
  s_add_u32 m0, s90, 32768
  s_add_u32 s77, s88, 212992
  buffer_load_dwordx4 v8, s[56:59], s77 offen lds
  buffer_load_dwordx4 v9, s[56:59], s77 offen offset:1024 lds
  s_add_u32 m0, s90, 40960
  s_add_u32 s77, s88, 229376
  buffer_load_dwordx4 v8, s[56:59], s77 offen lds
  buffer_load_dwordx4 v9, s[56:59], s77 offen offset:1024 lds
  s_add_u32 m0, s90, 49152
  s_add_u32 s77, s88, 245760
  buffer_load_dwordx4 v8, s[56:59], s77 offen lds
  buffer_load_dwordx4 v9, s[56:59], s77 offen offset:1024 lds
  s_load_dwordx16 s[16:31], s[40:41], s43 glc
  s_add_u32 m0, s90, 57344
  s_add_u32 s77, s88, 262144
  buffer_load_dwordx4 v8, s[56:59], s77 offen lds
  buffer_load_dwordx4 v9, s[56:59], s77 offen offset:1024 lds
  s_add_u32 m0, s90, 65536
  s_add_u32 s77, s88, 278528
  buffer_load_dwordx4 v8, s[56:59], s77 offen lds
  buffer_load_dwordx4 v9, s[56:59], s77 offen offset:1024 lds
  s_mov_b32 s92, s14
  s_mov_b32 s93, s14
  s_branch L_spe_88
L_sp_87:
  s_sleep 2
  s_load_dwordx16 s[16:31], s[40:41], s43 glc
L_spe_88:
  s_sub_u32 s76, s76, 1
  s_waitcnt lgkmcnt(0)
  s_bitcmp0_b32 s42, 0
  s_cselect_b64 s[24:25], s[92:93], s[24:25]
  s_xor_b64 s[16:17], s[16:17], s[92:93]
  s_xor_b64 s[18:19], s[18:19], s[92:93]
  s_xor_b64 s[20:21], s[20:21], s[92:93]
  s_xor_b64 s[22:23], s[22:23], s[92:93]
  s_xor_b64 s[24:25], s[24:25], s[92:93]
  s_or_b64 s[16:17], s[16:17], s[18:19]
  s_or_b64 s[16:17], s[16:17], s[20:21]
  s_or_b64 s[16:17], s[16:17], s[22:23]
  s_or_b64 s[16:17], s[16:17], s[24:25]
  s_cmp_gt_i32 s76, 0
  s_cselect_b64 s[16:17], s[16:17], 0
  s_cmp_eq_u64 s[16:17], 0
  s_cbranch_scc0 L_sp_87
  s_add_u32 s78, s91, 0
  buffer_load_dwordx4 v[16:19], v4, s[64:67], s78 offen offset:0 sc1
  buffer_load_dwordx4 v[20:23], v4, s[68:71], s78 offen offset:0 sc1
  buffer_load_dwordx4 v[24:27], v4, s[64:67], s78 offen offset:1024 sc1
  buffer_load_dwordx4 v[28:31], v4, s[68:71], s78 offen offset:1024 sc1
  buffer_load_dwordx4 v[32:35], v4, s[64:67], s78 offen offset:2048 sc1
  buffer_load_dwordx4 v[36:39], v4, s[68:71], s78 offen offset:2048 sc1
  buffer_load_dwordx4 v[40:43], v4, s[64:67], s78 offen offset:3072 sc1
  buffer_load_dwordx4 v[44:47], v4, s[68:71], s78 offen offset:3072 sc1
  s_add_u32 s78, s91, 4096
  buffer_load_dwordx4 v[48:51], v4, s[64:67], s78 offen offset:0 sc1
  buffer_load_dwordx4 v[52:55], v4, s[68:71], s78 offen offset:0 sc1
  s_setprio 0
  s_waitcnt vmcnt(8)
  v_mfma_f32_32x32x16_bf16 v[160:175], v[212:215], v[16:19], 0
  buffer_load_dwordx4 v[56:59], v4, s[64:67], s78 offen offset:1024 sc1
  buffer_load_dwordx4 v[60:63], v4, s[68:71], s78 offen offset:1024 sc1
  v_mfma_f32_32x32x16_bf16 v[176:191], v[208:211], v[20:23], 0
  v_mfma_f32_32x32x16_bf16 v[192:207], v[212:215], v[20:23], 0
  v_mfma_f32_32x32x16_bf16 v[144:159], v[208:211], v[16:19], 0
  s_waitcnt vmcnt(8)
  v_mfma_f32_32x32x16_bf16 v[160:175], v[220:223], v[24:27], v[160:175]
  buffer_load_dwordx4 v[64:67], v4, s[64:67], s78 offen offset:2048 sc1
  buffer_load_dwordx4 v[68:71], v4, s[68:71], s78 offen offset:2048 sc1
  v_mfma_f32_32x32x16_bf16 v[176:191], v[216:219], v[28:31], v[176:191]
  v_mfma_f32_32x32x16_bf16 v[192:207], v[220:223], v[28:31], v[192:207]
  v_mfma_f32_32x32x16_bf16 v[144:159], v[216:219], v[24:27], v[144:159]
  s_waitcnt vmcnt(8)
  v_mfma_f32_32x32x16_bf16 v[160:175], v[228:231], v[32:35], v[160:175]
  buffer_load_dwordx4 v[72:75], v4, s[64:67], s78 offen offset:3072 sc1
  buffer_load_dwordx4 v[76:79], v4, s[68:71], s78 offen offset:3072 sc1
  v_mfma_f32_32x32x16_bf16 v[176:191], v[224:227], v[36:39], v[176:191]
  v_mfma_f32_32x32x16_bf16 v[192:207], v[228:231], v[36:39], v[192:207]
  v_mfma_f32_32x32x16_bf16 v[144:159], v[224:227], v[32:35], v[144:159]
  s_waitcnt vmcnt(8)
  v_mfma_f32_32x32x16_bf16 v[160:175], v[236:239], v[40:43], v[160:175]
  s_add_u32 s78, s91, 8192
  buffer_load_dwordx4 v[80:83], v4, s[64:67], s78 offen offset:0 sc1
  buffer_load_dwordx4 v[84:87], v4, s[68:71], s78 offen offset:0 sc1
  v_mfma_f32_32x32x16_bf16 v[176:191], v[232:235], v[44:47], v[176:191]
  v_mfma_f32_32x32x16_bf16 v[192:207], v[236:239], v[44:47], v[192:207]
  v_mfma_f32_32x32x16_bf16 v[144:159], v[232:235], v[40:43], v[144:159]
  s_waitcnt vmcnt(8)
  v_mfma_f32_32x32x16_bf16 v[160:175], v[244:247], v[48:51], v[160:175]
  buffer_load_dwordx4 v[88:91], v4, s[64:67], s78 offen offset:1024 sc1
  buffer_load_dwordx4 v[92:95], v4, s[68:71], s78 offen offset:1024 sc1
  v_mfma_f32_32x32x16_bf16 v[176:191], v[240:243], v[52:55], v[176:191]
  v_mfma_f32_32x32x16_bf16 v[192:207], v[244:247], v[52:55], v[192:207]
  v_mfma_f32_32x32x16_bf16 v[144:159], v[240:243], v[48:51], v[144:159]
  s_waitcnt vmcnt(8)
  v_mfma_f32_32x32x16_bf16 v[160:175], v[252:255], v[56:59], v[160:175]
  buffer_load_dwordx4 v[96:99], v4, s[64:67], s78 offen offset:2048 sc1
  buffer_load_dwordx4 v[100:103], v4, s[68:71], s78 offen offset:2048 sc1
  v_mfma_f32_32x32x16_bf16 v[176:191], v[248:251], v[60:63], v[176:191]
  v_mfma_f32_32x32x16_bf16 v[192:207], v[252:255], v[60:63], v[192:207]
  v_mfma_f32_32x32x16_bf16 v[144:159], v[248:251], v[56:59], v[144:159]
  s_waitcnt vmcnt(8)
  v_mfma_f32_32x32x16_bf16 v[160:175], v[124:127], v[64:67], v[160:175]
  buffer_load_dwordx4 v[16:19], v4, s[64:67], s78 offen offset:3072 sc1
  buffer_load_dwordx4 v[20:23], v4, s[68:71], s78 offen offset:3072 sc1
  v_mfma_f32_32x32x16_bf16 v[176:191], v[120:123], v[68:71], v[176:191]
  v_lshrrev_b32 v237, 3, v0
  v_and_b32 v236, 7, v0
  v_mfma_f32_32x32x16_bf16 v[192:207], v[124:127], v[68:71], v[192:207]
  v_lshlrev_b32 v232, 1, v236
  v_xor_b32 v232, v232, v237
  v_mfma_f32_32x32x16_bf16 v[144:159], v[120:123], v[64:67], v[144:159]
  v_lshlrev_b32 v232, 4, v232
  v_lshl_add_u32 v232, v237, 8, v232
  s_waitcnt vmcnt(8)
  v_mfma_f32_32x32x16_bf16 v[160:175], v[132:135], v[72:75], v[160:175]
  ds_read_b64_tr_b16 v[104:105], v10 offset:0
  s_add_u32 s78, s91, 12288
  buffer_load_dwordx4 v[24:27], v4, s[64:67], s78 offen offset:0 sc1
  buffer_load_dwordx4 v[28:31], v4, s[68:71], s78 offen offset:0 sc1
  v_mfma_f32_32x32x16_bf16 v[176:191], v[128:131], v[76:79], v[176:191]
  ds_read_b64_tr_b16 v[106:107], v10 offset:1024
  s_lshl_b32 s15, s3, 11
  s_add_u32 s15, s15, 9344
  v_mfma_f32_32x32x16_bf16 v[192:207], v[132:135], v[76:79], v[192:207]
  ds_read_b64_tr_b16 v[108:109], v11 offset:0
  v_add_u32 v234, s15, v232
  v_xor_b32_e64 v235, 16, v234
  v_mfma_f32_32x32x16_bf16 v[144:159], v[128:131], v[72:75], v[144:159]
  ds_read_b64_tr_b16 v[110:111], v11 offset:1024
  s_lshl_b32 s15, s3, 13
  s_add_u32 s15, s15, 50688
  s_waitcnt vmcnt(8)
  v_mfma_f32_32x32x16_bf16 v[160:175], v[140:143], v[80:83], v[160:175]
  ds_read_b64_tr_b16 v[112:113], v10 offset:8192
  buffer_load_dwordx4 v[32:35], v4, s[64:67], s78 offen offset:1024 sc1
  buffer_load_dwordx4 v[36:39], v4, s[68:71], s78 offen offset:1024 sc1
  v_mfma_f32_32x32x16_bf16 v[176:191], v[136:139], v[84:87], v[176:191]
  ds_read_b64_tr_b16 v[114:115], v10 offset:9216
  v_add_u32 v232, s15, v232
  v_xor_b32 v233, 16, v232
  v_mfma_f32_32x32x16_bf16 v[192:207], v[140:143], v[84:87], v[192:207]
  ds_read_b64_tr_b16 v[116:117], v11 offset:8192
  v_lshlrev_b32_e64 v236, 4, v236
  v_lshl_add_u32 v238, v237, 10, v236
  v_mfma_f32_32x32x16_bf16 v[144:159], v[136:139], v[80:83], v[144:159]
  ds_read_b64_tr_b16 v[118:119], v11 offset:9216
  s_lshl_b32 s15, s3, 5
  s_add_u32 s15, s15, 128
  s_waitcnt vmcnt(8) lgkmcnt(4)
  v_mfma_f32_32x32x16_bf16 v[160:175], v[108:111], v[88:91], v[160:175]
  ds_read_b64_tr_b16 v[208:209], v10 offset:16384
  buffer_load_dwordx4 v[40:43], v4, s[64:67], s78 offen offset:2048 sc1
  buffer_load_dwordx4 v[44:47], v4, s[68:71], s78 offen offset:2048 sc1
  v_mfma_f32_32x32x16_bf16 v[176:191], v[104:107], v[92:95], v[176:191]
  ds_read_b64_tr_b16 v[210:211], v10 offset:17408
  v_lshl_add_u32 v236, v237, 2, s15
  s_lshl_b32 s43, s10, 16
  v_mfma_f32_32x32x16_bf16 v[192:207], v[108:111], v[92:95], v[192:207]
  ds_read_b64_tr_b16 v[212:213], v11 offset:16384
  s_lshl_b32 s15, s3, 13
  s_add_u32 s43, s43, s15
  v_mfma_f32_32x32x16_bf16 v[144:159], v[104:107], v[88:91], v[144:159]
  ds_read_b64_tr_b16 v[214:215], v11 offset:17408
  s_lshl_b32 s15, s11, 7
  s_add_u32 s43, s43, s15
  s_waitcnt vmcnt(8) lgkmcnt(4)
  v_mfma_f32_32x32x16_bf16 v[160:175], v[116:119], v[96:99], v[160:175]
  ds_read_b64_tr_b16 v[216:217], v10 offset:24576
  buffer_load_dwordx4 v[48:51], v4, s[64:67], s78 offen offset:3072 sc1
  buffer_load_dwordx4 v[52:55], v4, s[68:71], s78 offen offset:3072 sc1
  v_mfma_f32_32x32x16_bf16 v[176:191], v[112:115], v[100:103], v[176:191]
  ds_read_b64_tr_b16 v[218:219], v10 offset:25600
  v_and_b32 v224, 7, v0
  v_lshrrev_b32 v225, 5, v0
  v_mfma_f32_32x32x16_bf16 v[192:207], v[116:119], v[100:103], v[192:207]
  ds_read_b64_tr_b16 v[220:221], v11 offset:24576
  v_lshlrev_b32 v225, 2, v225
  v_xor_b32 v225, v225, v224
  v_mfma_f32_32x32x16_bf16 v[144:159], v[112:115], v[96:99], v[144:159]
  ds_read_b64_tr_b16 v[222:223], v11 offset:25600
  v_lshlrev_b32 v225, 4, v225
  v_lshl_add_u32 v225, v224, 8, v225
  s_waitcnt vmcnt(8) lgkmcnt(4)
  v_mfma_f32_32x32x16_bf16 v[160:175], v[212:215], v[16:19], v[160:175]
  ds_read_b64_tr_b16 v[240:241], v10 offset:32768
  s_add_u32 s78, s91, 16384
  buffer_load_dwordx4 v[56:59], v4, s[64:67], s78 offen offset:0 sc1
  buffer_load_dwordx4 v[60:63], v4, s[68:71], s78 offen offset:0 sc1
  v_mfma_f32_32x32x16_bf16 v[176:191], v[208:211], v[20:23], v[176:191]
  ds_read_b64_tr_b16 v[242:243], v10 offset:33792
  v_bfe_u32 v224, v0, 3, 2
  v_lshl_add_u32 v224, v224, 13, v225
  v_mfma_f32_32x32x16_bf16 v[192:207], v[212:215], v[20:23], v[192:207]
  ds_read_b64_tr_b16 v[244:245], v11 offset:32768
  v_add_u32 v224, s90, v224
  v_xor_b32 v225, 16, v224
  v_mfma_f32_32x32x16_bf16 v[144:159], v[208:211], v[16:19], v[144:159]
  ds_read_b64_tr_b16 v[246:247], v11 offset:33792
  v_xor_b32 v226, 32, v224
  v_xor_b32 v227, 48, v224
  s_waitcnt vmcnt(8) lgkmcnt(4)
  v_mfma_f32_32x32x16_bf16 v[160:175], v[220:223], v[24:27], v[160:175]
  ds_read_b64_tr_b16 v[248:249], v10 offset:40960
  buffer_load_dwordx4 v[64:67], v4, s[64:67], s78 offen offset:1024 sc1
  buffer_load_dwordx4 v[68:71], v4, s[68:71], s78 offen offset:1024 sc1
  v_mfma_f32_32x32x16_bf16 v[176:191], v[216:219], v[28:31], v[176:191]
  ds_read_b64_tr_b16 v[250:251], v10 offset:41984
  v_mfma_f32_32x32x16_bf16 v[192:207], v[220:223], v[28:31], v[192:207]
  ds_read_b64_tr_b16 v[252:253], v11 offset:40960
  v_mfma_f32_32x32x16_bf16 v[144:159], v[216:219], v[24:27], v[144:159]
  ds_read_b64_tr_b16 v[254:255], v11 offset:41984
  s_waitcnt vmcnt(8) lgkmcnt(4)
  v_mfma_f32_32x32x16_bf16 v[160:175], v[244:247], v[32:35], v[160:175]
  ds_read_b64_tr_b16 v[120:121], v10 offset:49152
  buffer_load_dwordx4 v[72:75], v4, s[64:67], s78 offen offset:2048 sc1
  buffer_load_dwordx4 v[76:79], v4, s[68:71], s78 offen offset:2048 sc1
  v_mfma_f32_32x32x16_bf16 v[176:191], v[240:243], v[36:39], v[176:191]
  ds_read_b64_tr_b16 v[122:123], v10 offset:50176
  v_mfma_f32_32x32x16_bf16 v[192:207], v[244:247], v[36:39], v[192:207]
  ds_read_b64_tr_b16 v[124:125], v11 offset:49152
  v_mfma_f32_32x32x16_bf16 v[144:159], v[240:243], v[32:35], v[144:159]
  ds_read_b64_tr_b16 v[126:127], v11 offset:50176
  s_waitcnt vmcnt(8) lgkmcnt(4)
  v_mfma_f32_32x32x16_bf16 v[160:175], v[252:255], v[40:43], v[160:175]
  ds_read_b64_tr_b16 v[104:105], v10 offset:57344
  buffer_load_dwordx4 v[80:83], v4, s[64:67], s78 offen offset:3072 sc1
  buffer_load_dwordx4 v[84:87], v4, s[68:71], s78 offen offset:3072 sc1
  v_mfma_f32_32x32x16_bf16 v[176:191], v[248:251], v[44:47], v[176:191]
  ds_read_b64_tr_b16 v[106:107], v10 offset:58368
  v_mfma_f32_32x32x16_bf16 v[192:207], v[252:255], v[44:47], v[192:207]
  ds_read_b64_tr_b16 v[108:109], v11 offset:57344
  v_mfma_f32_32x32x16_bf16 v[144:159], v[248:251], v[40:43], v[144:159]
  ds_read_b64_tr_b16 v[110:111], v11 offset:58368
  s_waitcnt vmcnt(8) lgkmcnt(4)
  v_mfma_f32_32x32x16_bf16 v[160:175], v[124:127], v[48:51], v[160:175]
  ds_read_b64_tr_b16 v[112:113], v12 offset:0
  s_add_u32 s78, s91, 20480
  buffer_load_dwordx4 v[88:91], v4, s[64:67], s78 offen offset:0 sc1
  buffer_load_dwordx4 v[92:95], v4, s[68:71], s78 offen offset:0 sc1
  v_mfma_f32_32x32x16_bf16 v[176:191], v[120:123], v[52:55], v[176:191]
  ds_read_b64_tr_b16 v[114:115], v12 offset:1024
  v_mfma_f32_32x32x16_bf16 v[192:207], v[124:127], v[52:55], v[192:207]
  ds_read_b64_tr_b16 v[116:117], v13 offset:0
  v_mfma_f32_32x32x16_bf16 v[144:159], v[120:123], v[48:51], v[144:159]
  ds_read_b64_tr_b16 v[118:119], v13 offset:1024
  s_waitcnt vmcnt(8) lgkmcnt(4)
  v_mfma_f32_32x32x16_bf16 v[160:175], v[108:111], v[56:59], v[160:175]
  ds_read_b64_tr_b16 v[208:209], v12 offset:8192
  buffer_load_dwordx4 v[96:99], v4, s[64:67], s78 offen offset:1024 sc1
  buffer_load_dwordx4 v[100:103], v4, s[68:71], s78 offen offset:1024 sc1
  v_mfma_f32_32x32x16_bf16 v[176:191], v[104:107], v[60:63], v[176:191]
  ds_read_b64_tr_b16 v[210:211], v12 offset:9216
  v_mfma_f32_32x32x16_bf16 v[192:207], v[108:111], v[60:63], v[192:207]
  ds_read_b64_tr_b16 v[212:213], v13 offset:8192
  v_mfma_f32_32x32x16_bf16 v[144:159], v[104:107], v[56:59], v[144:159]
  ds_read_b64_tr_b16 v[214:215], v13 offset:9216
  s_waitcnt vmcnt(8) lgkmcnt(4)
  v_mfma_f32_32x32x16_bf16 v[160:175], v[116:119], v[64:67], v[160:175]
  ds_read_b64_tr_b16 v[216:217], v12 offset:16384
  ds_read_b64_tr_b16 v[218:219], v12 offset:17408
  ds_read_b64_tr_b16 v[220:221], v13 offset:16384
  v_mfma_f32_32x32x16_bf16 v[176:191], v[112:115], v[68:71], v[176:191]
  ds_read_b64_tr_b16 v[222:223], v13 offset:17408
  ds_read_b64_tr_b16 v[240:241], v12 offset:24576
  ds_read_b64_tr_b16 v[242:243], v12 offset:25600
  v_mfma_f32_32x32x16_bf16 v[192:207], v[116:119], v[68:71], v[192:207]
  ds_read_b64_tr_b16 v[244:245], v13 offset:24576
  ds_read_b64_tr_b16 v[246:247], v13 offset:25600
  ds_read_b64_tr_b16 v[248:249], v12 offset:32768
  v_mfma_f32_32x32x16_bf16 v[144:159], v[112:115], v[64:67], v[144:159]
  ds_read_b64_tr_b16 v[250:251], v12 offset:33792
  ds_read_b64_tr_b16 v[252:253], v13 offset:32768
  ds_read_b64_tr_b16 v[254:255], v13 offset:33792
L_mmj:
  s_waitcnt vmcnt(0) lgkmcnt(0)
  v_mfma_f32_32x32x16_bf16 v[144:159], v[208:211], v[72:75], v[144:159]
  v_mfma_f32_32x32x16_bf16 v[144:159], v[216:219], v[80:83], v[144:159]
  v_mfma_f32_32x32x16_bf16 v[144:159], v[240:243], v[88:91], v[144:159]
  v_mfma_f32_32x32x16_bf16 v[144:159], v[248:251], v[96:99], v[144:159]
  v_mfma_f32_32x32x16_bf16 v[160:175], v[212:215], v[72:75], v[160:175]
  v_mfma_f32_32x32x16_bf16 v[160:175], v[220:223], v[80:83], v[160:175]
  v_mfma_f32_32x32x16_bf16 v[160:175], v[244:247], v[88:91], v[160:175]
  v_mfma_f32_32x32x16_bf16 v[160:175], v[252:255], v[96:99], v[160:175]
  s_nop 7
  ds_write_b128 v224, v[144:147] offset:0
  ds_write_b128 v225, v[148:151] offset:0
  ds_write_b128 v226, v[152:155] offset:0
  ds_write_b128 v227, v[156:159] offset:0
  v_mfma_f32_32x32x16_bf16 v[176:191], v[208:211], v[76:79], v[176:191]
  v_mfma_f32_32x32x16_bf16 v[176:191], v[216:219], v[84:87], v[176:191]
  v_mfma_f32_32x32x16_bf16 v[176:191], v[240:243], v[92:95], v[176:191]
  v_mfma_f32_32x32x16_bf16 v[176:191], v[248:251], v[100:103], v[176:191]
  ds_write_b128 v224, v[160:163] offset:128
  ds_write_b128 v225, v[164:167] offset:128
  ds_write_b128 v226, v[168:171] offset:128
  ds_write_b128 v227, v[172:175] offset:128
  v_mfma_f32_32x32x16_bf16 v[192:207], v[212:215], v[76:79], v[192:207]
  v_mfma_f32_32x32x16_bf16 v[192:207], v[220:223], v[84:87], v[192:207]
  v_mfma_f32_32x32x16_bf16 v[192:207], v[244:247], v[92:95], v[192:207]
  v_mfma_f32_32x32x16_bf16 v[192:207], v[252:255], v[100:103], v[192:207]
  s_nop 3
  ds_write_b128 v224, v[176:179] offset:32768
  ds_write_b128 v225, v[180:183] offset:32768
  ds_write_b128 v226, v[184:187] offset:32768
  ds_write_b128 v227, v[188:191] offset:32768
  s_nop 3
  ds_write_b128 v224, v[192:195] offset:32896
  ds_write_b128 v225, v[196:199] offset:32896
  ds_write_b128 v226, v[200:203] offset:32896
  ds_write_b128 v227, v[204:207] offset:32896
  s_waitcnt lgkmcnt(0)
  s_barrier
  ds_read_b32 v6, v236
  ds_read_b128 v[32:35], v232 offset:0
  ds_read_b128 v[36:39], v233 offset:0
  ds_read_b128 v[40:43], v232 offset:2048
  ds_read_b128 v[44:47], v233 offset:2048
  ds_read_b128 v[48:51], v232 offset:4096
  ds_read_b128 v[52:55], v233 offset:4096
  ds_read_b128 v[56:59], v232 offset:6144
  ds_read_b128 v[60:63], v233 offset:6144
  ds_read_b128 v[64:67], v234
  ds_read_b128 v[68:71], v235
  s_waitcnt lgkmcnt(6)
  v_pk_add_f32 v[32:33], v[32:33], v[40:41]
  v_pk_add_f32 v[34:35], v[34:35], v[42:43]
  v_pk_add_f32 v[36:37], v[36:37], v[44:45]
  v_pk_add_f32 v[38:39], v[38:39], v[46:47]
  s_waitcnt lgkmcnt(2)
  v_pk_add_f32 v[48:49], v[48:49], v[56:57]
  v_pk_add_f32 v[50:51], v[50:51], v[58:59]
  v_pk_add_f32 v[52:53], v[52:53], v[60:61]
  v_pk_add_f32 v[54:55], v[54:55], v[62:63]
  v_pk_add_f32 v[32:33], v[32:33], v[48:49]
  v_pk_add_f32 v[34:35], v[34:35], v[50:51]
  v_pk_add_f32 v[36:37], v[36:37], v[52:53]
  v_pk_add_f32 v[38:39], v[38:39], v[54:55]
  s_waitcnt lgkmcnt(0)
  v_pk_fma_f32 v[32:33], v[32:33], v[6:7], v[64:65] op_sel_hi:[1,0,1]
  v_pk_fma_f32 v[34:35], v[34:35], v[6:7], v[66:67] op_sel_hi:[1,0,1]
  v_pk_fma_f32 v[36:37], v[36:37], v[6:7], v[68:69] op_sel_hi:[1,0,1]
  v_pk_fma_f32 v[38:39], v[38:39], v[6:7], v[70:71] op_sel_hi:[1,0,1]
  v_cvt_pk_bf16_f32 v40, v32, v33
  v_cvt_pk_bf16_f32 v41, v34, v35
  v_cvt_pk_bf16_f32 v42, v36, v37
  v_cvt_pk_bf16_f32 v43, v38, v39
  buffer_store_dwordx4 v[40:43], v238, s[60:63], s43 offen sc1
  s_endpgm
L_codeend:

.section .rodata,"a"
.p2align 6
.amdhsa_kernel parallel_sum__ssm_conv_s4d__dense_activation_relu__prompt_kernel
  .amdhsa_next_free_vgpr 256
  .amdhsa_next_free_sgpr 102
  .amdhsa_accum_offset 256
  .amdhsa_group_segment_fixed_size 0
  .amdhsa_kernarg_size 104
  .amdhsa_user_sgpr_count 2
  .amdhsa_user_sgpr_kernarg_segment_ptr 1
  .amdhsa_system_sgpr_workgroup_id_x 1
  .amdhsa_float_denorm_mode_32 3
.end_amdhsa_kernel
```
